```python
import torch

def _softmax(x, axis=-1):
    return torch.softmax(x, dim=axis)
def _gelu(x):
    return torch.nn.functional.gelu(x, approximate="tanh")
def _silu(x):
    return torch.nn.functional.silu(x)
def _sigmoid(x):
    return torch.sigmoid(x)
def _layernorm(x, axis=-1, eps=1e-5):
    m = x.mean(dim=axis, keepdim=True)
    v = x.var(dim=axis, keepdim=True, unbiased=False)
    return (x - m) / torch.sqrt(v + eps)
def _scatter_add(tgt, idx, src, axis=0):
    return tgt.clone().index_add_(axis, idx, src)
def _segment_sum(src, seg, n):
    out = torch.zeros((n,) + src.shape[1:], dtype=src.dtype)
    return out.index_add_(0, seg, src)
def _pad(x, pw):
    flat = tuple(v for pair in reversed(pw) for v in pair)
    return torch.nn.functional.pad(x, flat)

kernel_name = 'gated_mix__ssm_conv_s4__dense_activation_squared_relu__prompt'

def setup_inputs():

    _w = (lambda a: (lambda t: t.to(torch.bfloat16) if t.is_floating_point() else t)(torch.as_tensor(a)))
    def _A_setup():
        B, L, D, N = 1, 2048, 640, 192
        A_re = -(lambda _x: torch.exp(torch.as_tensor(_x)))((lambda *s: torch.randn(*s, dtype=torch.bfloat16) * 6.4)(D, N))
        A_im = torch.pi * (lambda *s: torch.randn(*s, dtype=torch.bfloat16) * 0.1)(D, N)
        B_re = (lambda *s: torch.randn(*s, dtype=torch.bfloat16) * 0.2)(D, N)
        B_im = (lambda *s: torch.randn(*s, dtype=torch.bfloat16) * 0.2)(D, N)
        C_re = (lambda *s: torch.randn(*s, dtype=torch.bfloat16) * 0.2)(D, N)
        C_im = (lambda *s: torch.randn(*s, dtype=torch.bfloat16) * 0.2)(D, N)
        log_dt = (lambda *s: torch.randn(*s, dtype=torch.bfloat16) * 0.1)(D) * 0.5 - 4.0
        Dskip = (lambda *s: torch.randn(*s, dtype=torch.bfloat16) * 0.1)(D)
        return {
            "u": _w((lambda *s: torch.randn(*s, dtype=torch.bfloat16) * 0.05)(B, L, D)),
            "A_re": _w(A_re),
            "A_im": _w(A_im),
            "B_re": _w(B_re),
            "B_im": _w(B_im),
            "C_re": _w(C_re),
            "C_im": _w(C_im),
            "log_dt": _w(log_dt),
            "Dskip": _w(Dskip),
        }
    _A_in = _A_setup()

    def _B_setup():
        B, S, D, F = 1, 2048, 640, 1536
        return {
            "x": _w((lambda *s: torch.randn(*s, dtype=torch.bfloat16) * 0.05)(B, S, D)),
            "w1": _w((lambda *s: torch.randn(*s, dtype=torch.bfloat16) * 0.05)(D, F)),
            "b1": _w((lambda *s: torch.randn(*s, dtype=torch.bfloat16) * 0.05)(F)),
            "w2": _w((lambda *s: torch.randn(*s, dtype=torch.bfloat16) * 0.05)(F, D)),
            "b2": _w((lambda *s: torch.randn(*s, dtype=torch.bfloat16) * 0.05)(D)),
        }
    _B_in = _B_setup()

    return {
        "A_u": _A_in["u"],
        "A_A_re": _A_in["A_re"],
        "A_A_im": _A_in["A_im"],
        "A_B_re": _A_in["B_re"],
        "A_B_im": _A_in["B_im"],
        "A_C_re": _A_in["C_re"],
        "A_C_im": _A_in["C_im"],
        "A_log_dt": _A_in["log_dt"],
        "A_Dskip": _A_in["Dskip"],
        "B_x": _B_in["x"],
        "B_w1": _B_in["w1"],
        "B_b1": _B_in["b1"],
        "B_w2": _B_in["w2"],
        "B_b2": _B_in["b2"],
        "gate_w": _w((lambda *s: torch.randn(*s, dtype=torch.bfloat16) * 0.05)(640) * 16.0),
    }

def reference(A_u, A_A_re, A_A_im, A_B_re, A_B_im, A_C_re, A_C_im, A_log_dt, A_Dskip, B_x, B_w1, B_b1, B_w2, B_b2, gate_w):
    def _A_ref(u, A_re, A_im, B_re, B_im, C_re, C_im, log_dt, Dskip):
        Bsz, L, D = u.shape
        dt = torch.exp(log_dt)[:, None]
        A = A_re + 1j * A_im
        Bc = B_re + 1j * B_im
        Cc = C_re + 1j * C_im
        logdA = dt * A
        dB = dt * Bc
        l = (lambda x, dt: x.to(dt))(torch.arange(L), A_re.dtype)
        P = torch.exp(logdA[:, :, None] * l[None, None, :])
        K = torch.einsum("dn,dnl,dn->dl", Cc, P, dB).real
        L2 = 2 * L
        Kp = _pad(K, ((0, 0), (0, L)))
        up = (lambda x, *d: x.permute(*d))(u, 0, 2, 1)
        up = _pad(up, ((0, 0), (0, 0), (0, L)))
        Kf = (lambda x, axes=(-2,-1): torch.fft.rfft2(x.float(), dim=axes))(Kp[:, None, :], axes=(-2, -1))
        Uf = (lambda x, axes=(-2,-1): torch.fft.rfft2(x.float(), dim=axes))(up[:, :, None, :], axes=(-2, -1))
        Yf = Uf * Kf[None, :, :, :]
        y = (lambda x, s, axes=(-2,-1): torch.fft.irfft2(x, s=s, dim=axes).to(torch.bfloat16))(Yf, (1, L2), axes=(-2, -1))[:, :, 0, :L]
        y = (lambda x, *d: x.permute(*d))(y, 0, 2, 1) + u * Dskip[None, None, :]
        return y

    def _B_ref(x, w1, b1, w2, b2):
        h = torch.einsum("bsd,df->bsf", x, w1) + b1
        zero = torch.zeros_like(h)
        r = torch.where(h > zero, h, zero)
        h = r * r
        out = torch.einsum("bsf,fd->bsd", h, w2) + b2
        return out

    x = A_u
    g = _sigmoid((x * gate_w).sum(-1, keepdims=True))
    a = _A_ref(x, A_A_re, A_A_im, A_B_re, A_B_im, A_C_re, A_C_im, A_log_dt, A_Dskip)
    b = _B_ref(x, B_w1, B_b1, B_w2, B_b2)
    return g * a + (1 - g) * b
```

```asm
; @launch grid=(256,1,1) block=(512,1,1) lds=163840
.amdgcn_target "amdgcn-amd-amdhsa--gfx950"
.text
.globl gated_mix__ssm_conv_s4__dense_activation_squared_relu__prompt_kernel
.p2align 8
.type gated_mix__ssm_conv_s4__dense_activation_squared_relu__prompt_kernel,@function
gated_mix__ssm_conv_s4__dense_activation_squared_relu__prompt_kernel:
    s_cmp_ge_u32 s2, 256
    s_cbranch_scc1 L_end
    s_load_dwordx16 s[4:19], s[0:1], 0
    s_load_dwordx16 s[20:35], s[0:1], 64
    s_load_dwordx4 s[36:39], s[0:1], 128
    v_cmp_gt_u32 vcc, 8, v0
    s_getpc_b64 s[92:93]
L_pc:
    v_lshlrev_b32 v3, 12, v0
    s_cbranch_vccz L_nopf
    s_mov_b32 s94, L_end - L_pc
    s_mov_b32 s95, 0x20000
    s_lshl_b32 s3, s2, 4
    s_mov_b64 exec, 0xff
    buffer_load_dword v253, v3, s[92:95], s3 offen
    s_mov_b64 exec, -1
L_nopf:
    v_lshrrev_b32 v2, 6, v0
    v_and_b32 v1, 63, v0
    v_readfirstlane_b32 s40, v2
    s_lshl_b32 s41, s2, 2
    s_and_b32 s41, s41, 24
    s_lshr_b32 s44, s2, 5
    s_add_u32 s41, s41, s44
    s_lshl_b32 s42, s2, 2
    s_and_b32 s42, s42, 4
    s_bfe_u32 s44, s2, 0x20003
    s_add_u32 s42, s42, s44
    s_and_b32 s98, s41, 3
    s_lshl_b32 s98, s98, 1
    s_add_u32 s98, s98, s42
    s_and_b32 s98, s98, 7
    s_cmp_lt_u32 s40, 4
    s_cbranch_scc1 L_gemm
    s_cmp_eq_u32 s40, 7
    s_cbranch_scc1 L_help
L_conv:
    s_setprio 1
    s_sub_u32 s68, s40, 4
    s_and_b32 s45, s41, 1
    s_add_u32 s44, s45, s68
    s_cmp_ge_u32 s44, 3
    s_cbranch_scc1 L_rt
    s_lshr_b32 s69, s41, 1
    s_mul_i32 s69, s69, 5
    s_mul_i32 s45, s45, 3
    s_add_u32 s69, s69, s45
    s_add_u32 s73, s69, s68
    s_mul_i32 s44, s42, 80
    s_add_u32 s69, s73, s44
    s_mul_i32 s44, s69, 384
    v_lshl_add_u32 v41, v1, 2, s44
    v_lshl_add_u32 v42, v1, 1, s44
    s_lshl_b32 s44, s69, 1
    v_mov_b32 v43, s44
    s_waitcnt lgkmcnt(0)
    global_load_ushort v46, v43, s[18:19]
    global_load_ushort v47, v43, s[20:21]
    global_load_dword v48, v41, s[6:7]
    global_load_dword v49, v41, s[8:9]
    global_load_dword v50, v41, s[10:11]
    global_load_dword v51, v41, s[12:13]
    global_load_dword v52, v41, s[14:15]
    global_load_dword v53, v41, s[16:17]
    global_load_ushort v54, v42, s[6:7] offset:256
    global_load_ushort v55, v42, s[8:9] offset:256
    global_load_ushort v56, v42, s[10:11] offset:256
    global_load_ushort v57, v42, s[12:13] offset:256
    global_load_ushort v58, v42, s[14:15] offset:256
    global_load_ushort v59, v42, s[16:17] offset:256
    s_barrier
    s_branch L_conv_body
L_rt:
    s_setprio 3
    s_barrier
    s_branch L_rt_body
L_help:
    s_setprio 3
    v_mov_b32 v11, 27648
    v_mov_b32 v56, 0
    v_mov_b32 v57, 0
    v_mov_b32 v58, 0
    v_mov_b32 v59, 0
    ds_write_b128 v11, v[56:59]
    ds_write_b128 v11, v[56:59] offset:16
    v_lshlrev_b32 v7, 4, v1
    v_mov_b32 v15, 1
    s_mul_i32 s46, s42, 384
    s_waitcnt lgkmcnt(0)
    s_mov_b32 s60, s26
    s_mov_b32 s61, s27
    s_mov_b32 s62, 0xc00
    s_mov_b32 s63, 0x20000
    s_mov_b32 m0, 161024
    s_mov_b64 exec, 0xffffff
    buffer_load_dwordx4 v7, s[60:63], s46 offen lds
    s_mov_b64 exec, -1
    s_barrier
    s_branch L_help_body
L_gemm:
    s_setprio 2
    v_lshrrev_b32 v12, 3, v1
    v_lshrrev_b32 v13, 4, v1
    v_and_b32 v14, 7, v1
    v_xor_b32 v14, v14, v13
    v_lshlrev_b32 v14, 4, v14
    v_mul_u32_u24 v12, 1280, v12
    v_add_u32 v3, v12, v14
    v_xor_b32 v4, 64, v3
    v_add_u32 v4, 9216, v4
    s_mul_i32 s83, s98, 5
    s_lshr_b32 s83, s83, 2
    s_lshl_b32 s68, s41, 2
    s_add_u32 s68, s68, s40
    s_mul_i32 s68, s68, 20480
    s_add_u32 s82, s68, 1280
    s_lshl_b32 s81, s83, 7
    s_add_u32 s81, s81, s68
    s_lshl_b32 s71, s42, 2
    s_add_u32 s71, s71, s40
    s_mul_i32 s69, s71, 96
    s_mul_i32 s44, s83, 196608
    s_add_u32 s69, s69, s44
    s_mul_i32 s70, s40, 12288
    s_add_u32 s70, s70, 110592
    s_lshl_b32 s80, s40, 11
    s_add_u32 s80, s80, 28672
    s_waitcnt lgkmcnt(0)
    s_mov_b32 s56, s4
    s_mov_b32 s57, s5
    s_mov_b32 s58, 0x280000
    s_mov_b32 s59, 0x20000
    s_mov_b32 s60, s24
    s_mov_b32 s61, s25
    s_mov_b32 s62, 0x1e0000
    s_mov_b32 s63, 0x20000
    s_barrier
    s_add_u32 m0, s80, 0
    s_nop 0
    buffer_load_dwordx4 v3, s[56:59], s81 offen lds
    buffer_load_dwordx4 v4, s[56:59], s81 offen offset:1024 lds
    s_add_u32 s81, s81, 128
    s_cmp_eq_u32 s81, s82
    s_cselect_b32 s81, s68, s81
L_gemm_body:
    s_add_u32 m0, s80, 8192
    s_nop 0
    buffer_load_dwordx4 v3, s[56:59], s81 offen lds
    buffer_load_dwordx4 v4, s[56:59], s81 offen offset:1024 lds
    s_add_u32 s81, s81, 128
    s_cmp_eq_u32 s81, s82
    s_cselect_b32 s81, s68, s81
    v_mul_u32_u24 v13, 21846, v1
    v_lshrrev_b32 v13, 16, v13
    v_mul_u32_u24 v14, 3, v13
    v_sub_u32 v14, v1, v14
    s_and_b32 s44, s41, 31
    s_lshl_b32 s44, s44, 2
    s_add_u32 s44, s44, s40
    s_mul_i32 s44, s44, 15360
    s_mul_i32 s45, s42, 384
    s_add_u32 s44, s44, s45
    v_mul_u32_u24 v13, 3072, v13
    v_lshl_add_u32 v13, v14, 7, v13
    s_mov_b64 exec, 0x7fff
    buffer_load_dword v254, v13, s[60:63], s44 offen
    s_mov_b64 exec, -1
    v_mul_u32_u24 v13, 10923, v1
    v_lshrrev_b32 v13, 16, v13
    v_mul_u32_u24 v14, 6, v13
    v_sub_u32 v14, v1, v14
    v_and_b32 v5, 19, v13
    v_lshrrev_b32 v12, 1, v13
    v_and_or_b32 v5, v12, 4, v5
    v_lshlrev_b32 v12, 1, v13
    v_and_or_b32 v5, v12, 8, v5
    v_mul_u32_u24 v5, 3072, v5
    v_lshl_add_u32 v5, v14, 4, v5
    v_add_u32 v12, 64, v1
    v_mul_u32_u24 v13, 10923, v12
    v_lshrrev_b32 v13, 16, v13
    v_mul_u32_u24 v14, 6, v13
    v_sub_u32 v14, v12, v14
    v_and_b32 v6, 19, v13
    v_lshrrev_b32 v12, 1, v13
    v_and_or_b32 v6, v12, 4, v6
    v_lshlrev_b32 v12, 1, v13
    v_and_or_b32 v6, v12, 8, v6
    v_mul_u32_u24 v6, 3072, v6
    v_lshl_add_u32 v6, v14, 4, v6
    v_subrev_u32 v6, 1024, v6
    v_add_u32 v12, 128, v1
    v_mul_u32_u24 v13, 10923, v12
    v_lshrrev_b32 v13, 16, v13
    v_mul_u32_u24 v14, 6, v13
    v_sub_u32 v14, v12, v14
    v_and_b32 v7, 19, v13
    v_lshrrev_b32 v12, 1, v13
    v_and_or_b32 v7, v12, 4, v7
    v_lshlrev_b32 v12, 1, v13
    v_and_or_b32 v7, v12, 8, v7
    v_mul_u32_u24 v7, 3072, v7
    v_lshl_add_u32 v7, v14, 4, v7
    v_subrev_u32 v7, 2048, v7
    v_lshlrev_b32 v2, 4, v1
    v_add_u32 v15, 4096, v2
    v_mov_b32 v10, 27648
    v_mov_b32 v0, 1
    s_and_b32 s79, s40, 1
    s_lshl_b32 s51, s79, 5
    s_lshl_b32 s3, s79, 6
    s_sub_u32 s3, 64, s3
    v_lshrrev_b32 v13, 4, v1
    s_mul_i32 s44, s40, 96
    s_add_u32 s44, s44, 161024
    v_lshl_add_u32 v12, v13, 3, s44
    v_add_u32 v28, s51, v12
    v_add_u32 v29, s3, v12
    v_lshrrev_b32 v12, 5, v1
    v_lshlrev_b32 v12, 4, v12
    v_bfe_u32 v14, v1, 2, 3
    v_add_u32 v12, v12, v14
    v_mul_u32_u24 v12, 96, v12
    v_and_b32 v14, 3, v1
    v_lshl_add_u32 v12, v14, 3, v12
    v_add_u32 v12, s70, v12
    v_add_u32 v8, s51, v12
    v_add_u32 v9, s3, v12
    v_and_b32 v12, 15, v1
    v_lshrrev_b32 v14, 1, v12
    v_xor_b32 v14, v14, v13
    v_lshlrev_b32 v14, 4, v14
    v_lshl_add_u32 v12, v12, 7, v14
    v_xor_b32 v14, 64, v12
    v_add_u32 v194, s80, v12
    v_add_u32 v195, s80, v14
    s_lshr_b32 s45, s42, 1
    s_xor_b32 s44, s79, 0
    s_lshl_b32 s73, s44, 10
    s_xor_b32 s44, s44, s45
    s_lshl_b32 s44, s44, 11
    s_add_u32 s44, s44, 28672
    v_add_u32 v184, s44, v12
    v_add_u32 v185, s44, v14
    s_xor_b32 s44, s79, 1
    s_lshl_b32 s74, s44, 10
    s_xor_b32 s44, s44, s45
    s_lshl_b32 s44, s44, 11
    s_add_u32 s44, s44, 28672
    v_add_u32 v186, s44, v12
    v_add_u32 v187, s44, v14
    s_xor_b32 s44, s79, 2
    s_lshl_b32 s75, s44, 10
    s_xor_b32 s44, s44, s45
    s_lshl_b32 s44, s44, 11
    s_add_u32 s44, s44, 28672
    v_add_u32 v188, s44, v12
    v_add_u32 v189, s44, v14
    s_xor_b32 s44, s79, 3
    s_lshl_b32 s76, s44, 10
    s_xor_b32 s44, s44, s45
    s_lshl_b32 s44, s44, 11
    s_add_u32 s44, s44, 28672
    v_add_u32 v190, s44, v12
    v_add_u32 v191, s44, v14
    s_mul_i32 s72, s41, 196608
    s_add_u32 s72, s72, 8912896
    s_lshr_b32 s45, s71, 1
    s_mul_i32 s45, s45, 12288
    s_add_u32 s45, s45, s72
    s_lshl_b32 s46, s79, 13
    s_add_u32 s46, s46, s45
    s_add_u32 s45, s45, 4096
    s_add_u32 s77, s73, s45
    s_add_u32 s78, s75, s45
    s_add_u32 s73, s73, s46
    s_add_u32 s74, s74, s46
    s_add_u32 s75, s75, s46
    s_add_u32 s76, s76, s46
    s_mul_i32 s44, s40, 49152
    s_add_u32 s72, s72, s44
    s_mul_i32 s71, s71, 61440
    s_add_u32 s71, s71, 6815744
    s_and_b32 s44, s41, 3
    s_add_u32 s44, s44, 0
    s_and_b32 s44, s44, 3
    s_mul_i32 s45, s44, 15360
    s_add_u32 s16, s45, s71
    s_mul_i32 s45, s44, 12288
    s_add_u32 s20, s45, s72
    s_and_b32 s44, s41, 3
    s_add_u32 s44, s44, 1
    s_and_b32 s44, s44, 3
    s_mul_i32 s45, s44, 15360
    s_add_u32 s17, s45, s71
    s_mul_i32 s45, s44, 12288
    s_add_u32 s21, s45, s72
    s_and_b32 s44, s41, 3
    s_add_u32 s44, s44, 2
    s_and_b32 s44, s44, 3
    s_mul_i32 s45, s44, 15360
    s_add_u32 s18, s45, s71
    s_mul_i32 s45, s44, 12288
    s_add_u32 s22, s45, s72
    s_and_b32 s44, s41, 3
    s_add_u32 s44, s44, 3
    s_and_b32 s44, s44, 3
    s_mul_i32 s45, s44, 15360
    s_add_u32 s19, s45, s71
    s_mul_i32 s45, s44, 12288
    s_add_u32 s23, s45, s72
    s_mul_i32 s50, s40, 20480
    s_add_u32 s50, s50, 28672
    s_mov_b32 s52, s38
    s_mov_b32 s53, s39
    s_mov_b32 s54, 0x1000000
    s_mov_b32 s55, 0x20000
    s_add_u32 m0, s80, 16384
    s_nop 0
    buffer_load_dwordx4 v3, s[56:59], s81 offen lds
    buffer_load_dwordx4 v4, s[56:59], s81 offen offset:1024 lds
    s_add_u32 s81, s81, 128
    s_cmp_eq_u32 s81, s82
    s_cselect_b32 s81, s68, s81
    s_waitcnt vmcnt(3)
    s_mov_b64 exec, 1
    ds_add_u32 v10, v0 offset:0
    s_mov_b64 exec, -1
    s_add_u32 m0, s80, 24576
    s_nop 0
    buffer_load_dwordx4 v3, s[56:59], s81 offen lds
    buffer_load_dwordx4 v4, s[56:59], s81 offen offset:1024 lds
    s_add_u32 s81, s81, 128
    s_cmp_eq_u32 s81, s82
    s_cselect_b32 s81, s68, s81
    s_add_u32 m0, s80, 32768
    s_nop 0
    buffer_load_dwordx4 v3, s[56:59], s81 offen lds
    buffer_load_dwordx4 v4, s[56:59], s81 offen offset:1024 lds
    s_add_u32 s81, s81, 128
    s_cmp_eq_u32 s81, s82
    s_cselect_b32 s81, s68, s81
    s_add_u32 m0, s80, 40960
    s_waitcnt vmcnt(6)
    buffer_load_dwordx4 v3, s[56:59], s81 offen lds
    s_waitcnt vmcnt(6)
    buffer_load_dwordx4 v4, s[56:59], s81 offen offset:1024 lds
    s_add_u32 s81, s81, 128
    s_cmp_eq_u32 s81, s82
    s_cselect_b32 s81, s68, s81
    s_waitcnt lgkmcnt(0)
    s_mov_b32 s48, 0
L_spin_1:
    ds_read_b32 v11, v10 offset:0
    s_add_u32 s48, s48, 1
    s_waitcnt lgkmcnt(0)
    v_readfirstlane_b32 s44, v11
    s_nop 0
    s_cmp_ge_u32 s44, 5
    s_cbranch_scc1 L_spun_2
    s_cmp_lt_u32 s48, 400000
    s_cbranch_scc1 L_spin_1
L_spun_2:
    ds_read_b64 v[248:249], v28
    ds_read_b64 v[250:251], v28 offset:32
    ds_read_b64 v[252:253], v29
    s_waitcnt lgkmcnt(2)
    v_lshlrev_b32 v16, 16, v248
    v_and_b32 v17, 0xffff0000, v248
    v_lshlrev_b32 v18, 16, v249
    v_and_b32 v19, 0xffff0000, v249
    s_waitcnt lgkmcnt(1)
    v_lshlrev_b32 v20, 16, v250
    v_and_b32 v21, 0xffff0000, v250
    v_lshlrev_b32 v22, 16, v251
    v_and_b32 v23, 0xffff0000, v251
    s_waitcnt lgkmcnt(0)
    v_lshlrev_b32 v24, 16, v252
    v_and_b32 v25, 0xffff0000, v252
    v_lshlrev_b32 v26, 16, v253
    v_and_b32 v27, 0xffff0000, v253
    s_lshl_b32 s44, s41, 7
    s_add_u32 s44, s44, 1024
    s_load_dword s99, s[38:39], s44
    s_add_u32 m0, s80, 49152
    s_waitcnt vmcnt(6)
    buffer_load_dwordx4 v3, s[56:59], s81 offen lds
    s_waitcnt vmcnt(6)
    buffer_load_dwordx4 v4, s[56:59], s81 offen offset:1024 lds
    s_add_u32 s81, s81, 128
    s_cmp_eq_u32 s81, s82
    s_cselect_b32 s81, s68, s81
    s_add_u32 m0, s80, 57344
    s_waitcnt vmcnt(6)
    buffer_load_dwordx4 v3, s[56:59], s81 offen lds
    s_waitcnt vmcnt(6)
    buffer_load_dwordx4 v4, s[56:59], s81 offen offset:1024 lds
    s_add_u32 s81, s81, 128
    s_cmp_eq_u32 s81, s82
    s_cselect_b32 s81, s68, s81
    s_add_u32 m0, s80, 65536
    s_waitcnt vmcnt(6)
    buffer_load_dwordx4 v3, s[56:59], s81 offen lds
    s_waitcnt vmcnt(6)
    buffer_load_dwordx4 v4, s[56:59], s81 offen offset:1024 lds
    s_add_u32 s81, s81, 128
    s_cmp_eq_u32 s81, s82
    s_cselect_b32 s81, s68, s81
    s_add_u32 m0, s80, 73728
    s_waitcnt vmcnt(6)
    buffer_load_dwordx4 v3, s[56:59], s81 offen lds
    s_waitcnt vmcnt(6)
    buffer_load_dwordx4 v4, s[56:59], s81 offen offset:1024 lds
    s_add_u32 s81, s81, 128
    s_cmp_eq_u32 s81, s82
    s_cselect_b32 s81, s68, s81
    s_add_u32 m0, s70, 0
    s_waitcnt vmcnt(6)
    buffer_load_dwordx4 v5, s[60:63], s69 offen offset:0 lds
    s_waitcnt vmcnt(6)
    buffer_load_dwordx4 v6, s[60:63], s69 offen offset:1024 lds
    s_waitcnt vmcnt(6)
    buffer_load_dwordx4 v7, s[60:63], s69 offen offset:2048 lds
    s_add_u32 s69, s69, 98304
    s_add_u32 m0, s70, 3072
    s_waitcnt vmcnt(6)
    buffer_load_dwordx4 v5, s[60:63], s69 offen offset:0 lds
    s_waitcnt vmcnt(6)
    buffer_load_dwordx4 v6, s[60:63], s69 offen offset:1024 lds
    s_waitcnt vmcnt(6)
    buffer_load_dwordx4 v7, s[60:63], s69 offen offset:2048 lds
    s_add_u32 s69, s69, 98304
    s_cmp_ge_u32 s69, 1966080
    s_cselect_b32 s47, 1966080, 0
    s_sub_u32 s69, s69, s47
    s_add_u32 m0, s70, 6144
    s_waitcnt vmcnt(6)
    buffer_load_dwordx4 v5, s[60:63], s69 offen offset:0 lds
    s_mov_b64 exec, 1
    ds_add_u32 v10, v0 offset:8
    s_mov_b64 exec, -1
    s_waitcnt vmcnt(6)
    buffer_load_dwordx4 v6, s[60:63], s69 offen offset:1024 lds
    s_waitcnt vmcnt(6)
    buffer_load_dwordx4 v7, s[60:63], s69 offen offset:2048 lds
    s_add_u32 s69, s69, 98304
    s_add_u32 m0, s70, 9216
    s_waitcnt vmcnt(6)
    buffer_load_dwordx4 v5, s[60:63], s69 offen offset:0 lds
    s_waitcnt vmcnt(6)
    buffer_load_dwordx4 v6, s[60:63], s69 offen offset:1024 lds
    s_waitcnt vmcnt(6)
    buffer_load_dwordx4 v7, s[60:63], s69 offen offset:2048 lds
    s_add_u32 s69, s69, 98304
    s_cmp_ge_u32 s69, 1966080
    s_cselect_b32 s47, 1966080, 0
    s_sub_u32 s69, s69, s47
    ds_read_b64_tr_b16 v[160:161], v8 offset:0
    ds_read_b64_tr_b16 v[162:163], v8 offset:768
    ds_read_b64_tr_b16 v[164:165], v8 offset:32
    ds_read_b64_tr_b16 v[166:167], v8 offset:800
    ds_read_b64_tr_b16 v[168:169], v9 offset:0
    ds_read_b64_tr_b16 v[170:171], v9 offset:768
    s_waitcnt lgkmcnt(0)
    s_mov_b32 s48, 0
L_spin_3:
    ds_read_b32 v11, v10 offset:8
    s_add_u32 s48, s48, 1
    s_waitcnt lgkmcnt(0)
    v_readfirstlane_b32 s44, v11
    s_nop 0
    s_cmp_ge_u32 s44, 4
    s_cbranch_scc1 L_spun_4
    s_cmp_lt_u32 s48, 400000
    s_cbranch_scc1 L_spin_3
L_spun_4:
    ds_read_b128 v[116:119], v184 offset:0
    ds_read_b128 v[120:123], v186 offset:0
    ds_read_b128 v[124:127], v188 offset:0
    ds_read_b128 v[128:131], v190 offset:0
    s_waitcnt vmcnt(6)
    ds_read_b64_tr_b16 v[132:133], v8 offset:3072
    ds_read_b64_tr_b16 v[134:135], v8 offset:3840
    ds_read_b64_tr_b16 v[136:137], v8 offset:3104
    ds_read_b64_tr_b16 v[138:139], v8 offset:3872
    ds_read_b64_tr_b16 v[140:141], v9 offset:3072
    ds_read_b64_tr_b16 v[142:143], v9 offset:3840
    s_add_u32 m0, s70, 0
    s_nop 0
    buffer_load_dwordx4 v5, s[60:63], s69 offen offset:0 lds
    s_waitcnt vmcnt(6)
    buffer_load_dwordx4 v6, s[60:63], s69 offen offset:1024 lds
    s_waitcnt vmcnt(6)
    buffer_load_dwordx4 v7, s[60:63], s69 offen offset:2048 lds
    s_add_u32 s69, s69, 98304
    s_waitcnt lgkmcnt(6)
    v_mfma_f32_16x16x32_bf16 v[196:199], v[160:163], v[116:119], v[16:19]
    ds_read_b128 v[144:147], v185 offset:0
    v_mfma_f32_16x16x32_bf16 v[200:203], v[160:163], v[120:123], v[16:19]
    ds_read_b128 v[148:151], v187 offset:0
    v_mfma_f32_16x16x32_bf16 v[204:207], v[160:163], v[124:127], v[16:19]
    ds_read_b128 v[152:155], v189 offset:0
    s_add_u32 m0, s70, 3072
    s_waitcnt lgkmcnt(3)
    v_mfma_f32_16x16x32_bf16 v[208:211], v[160:163], v[128:131], v[16:19]
    buffer_load_dwordx4 v5, s[60:63], s69 offen offset:0 lds
    v_mfma_f32_16x16x32_bf16 v[212:215], v[164:167], v[116:119], v[20:23]
    ds_read_b128 v[156:159], v191 offset:0
    s_waitcnt vmcnt(7)
    v_mfma_f32_16x16x32_bf16 v[216:219], v[164:167], v[120:123], v[20:23]
    ds_read_b64_tr_b16 v[172:173], v8 offset:6144
    v_mfma_f32_16x16x32_bf16 v[220:223], v[164:167], v[124:127], v[20:23]
    ds_read_b64_tr_b16 v[174:175], v8 offset:6912
    ds_read_b64_tr_b16 v[176:177], v8 offset:6176
    v_mfma_f32_16x16x32_bf16 v[224:227], v[164:167], v[128:131], v[20:23]
    buffer_load_dwordx4 v6, s[60:63], s69 offen offset:1024 lds
    v_mfma_f32_16x16x32_bf16 v[228:231], v[168:171], v[116:119], v[24:27]
    ds_read_b64_tr_b16 v[178:179], v8 offset:6944
    v_mfma_f32_16x16x32_bf16 v[232:235], v[168:171], v[120:123], v[24:27]
    ds_read_b64_tr_b16 v[180:181], v9 offset:6144
    v_mfma_f32_16x16x32_bf16 v[236:239], v[168:171], v[124:127], v[24:27]
    buffer_load_dwordx4 v7, s[60:63], s69 offen offset:2048 lds
    v_mfma_f32_16x16x32_bf16 v[240:243], v[168:171], v[128:131], v[24:27]
    ds_read_b64_tr_b16 v[182:183], v9 offset:6912
    s_waitcnt lgkmcnt(6)
    v_mfma_f32_16x16x32_bf16 v[196:199], v[132:135], v[144:147], v[196:199]
    ds_read_b128 v[116:119], v184 offset:8192
    s_add_u32 s69, s69, 98304
    s_cmp_ge_u32 s69, 1966080
    v_mfma_f32_16x16x32_bf16 v[200:203], v[132:135], v[148:151], v[200:203]
    ds_read_b128 v[120:123], v186 offset:8192
    s_cselect_b32 s47, 1966080, 0
    s_sub_u32 s69, s69, s47
    v_mfma_f32_16x16x32_bf16 v[204:207], v[132:135], v[152:155], v[204:207]
    ds_read_b128 v[124:127], v188 offset:8192
    s_add_u32 m0, s70, 6144
    s_waitcnt lgkmcnt(3)
    v_mfma_f32_16x16x32_bf16 v[208:211], v[132:135], v[156:159], v[208:211]
    buffer_load_dwordx4 v5, s[60:63], s69 offen offset:0 lds
    v_mfma_f32_16x16x32_bf16 v[212:215], v[136:139], v[144:147], v[212:215]
    ds_read_b128 v[128:131], v190 offset:8192
    s_waitcnt vmcnt(7)
    v_mfma_f32_16x16x32_bf16 v[216:219], v[136:139], v[148:151], v[216:219]
    ds_read_b64_tr_b16 v[160:161], v8 offset:9216
    v_mfma_f32_16x16x32_bf16 v[220:223], v[136:139], v[152:155], v[220:223]
    ds_read_b64_tr_b16 v[162:163], v8 offset:9984
    ds_read_b64_tr_b16 v[164:165], v8 offset:9248
    v_mfma_f32_16x16x32_bf16 v[224:227], v[136:139], v[156:159], v[224:227]
    buffer_load_dwordx4 v6, s[60:63], s69 offen offset:1024 lds
    v_mfma_f32_16x16x32_bf16 v[228:231], v[140:143], v[144:147], v[228:231]
    ds_read_b64_tr_b16 v[166:167], v8 offset:10016
    v_mfma_f32_16x16x32_bf16 v[232:235], v[140:143], v[148:151], v[232:235]
    ds_read_b64_tr_b16 v[168:169], v9 offset:9216
    v_mfma_f32_16x16x32_bf16 v[236:239], v[140:143], v[152:155], v[236:239]
    buffer_load_dwordx4 v7, s[60:63], s69 offen offset:2048 lds
    v_mfma_f32_16x16x32_bf16 v[240:243], v[140:143], v[156:159], v[240:243]
    ds_read_b64_tr_b16 v[170:171], v9 offset:9984
    s_waitcnt lgkmcnt(6)
    v_mfma_f32_16x16x32_bf16 v[196:199], v[172:175], v[116:119], v[196:199]
    ds_read_b128 v[144:147], v185 offset:8192
    s_add_u32 s69, s69, 98304
    v_mfma_f32_16x16x32_bf16 v[200:203], v[172:175], v[120:123], v[200:203]
    ds_read_b128 v[148:151], v187 offset:8192
    v_mfma_f32_16x16x32_bf16 v[204:207], v[172:175], v[124:127], v[204:207]
    ds_read_b128 v[152:155], v189 offset:8192
    s_add_u32 m0, s70, 9216
    s_waitcnt lgkmcnt(3)
    v_mfma_f32_16x16x32_bf16 v[208:211], v[172:175], v[128:131], v[208:211]
    buffer_load_dwordx4 v5, s[60:63], s69 offen offset:0 lds
    v_mfma_f32_16x16x32_bf16 v[212:215], v[176:179], v[116:119], v[212:215]
    ds_read_b128 v[156:159], v191 offset:8192
    s_waitcnt vmcnt(7)
    v_mfma_f32_16x16x32_bf16 v[216:219], v[176:179], v[120:123], v[216:219]
    ds_read_b64_tr_b16 v[132:133], v8 offset:0
    v_mfma_f32_16x16x32_bf16 v[220:223], v[176:179], v[124:127], v[220:223]
    ds_read_b64_tr_b16 v[134:135], v8 offset:768
    ds_read_b64_tr_b16 v[136:137], v8 offset:32
    v_mfma_f32_16x16x32_bf16 v[224:227], v[176:179], v[128:131], v[224:227]
    buffer_load_dwordx4 v6, s[60:63], s69 offen offset:1024 lds
    v_mfma_f32_16x16x32_bf16 v[228:231], v[180:183], v[116:119], v[228:231]
    ds_read_b64_tr_b16 v[138:139], v8 offset:800
    v_mfma_f32_16x16x32_bf16 v[232:235], v[180:183], v[120:123], v[232:235]
    ds_read_b64_tr_b16 v[140:141], v9 offset:0
    v_mfma_f32_16x16x32_bf16 v[236:239], v[180:183], v[124:127], v[236:239]
    buffer_load_dwordx4 v7, s[60:63], s69 offen offset:2048 lds
    v_mfma_f32_16x16x32_bf16 v[240:243], v[180:183], v[128:131], v[240:243]
    ds_read_b64_tr_b16 v[142:143], v9 offset:768
    s_waitcnt lgkmcnt(6)
    v_mfma_f32_16x16x32_bf16 v[196:199], v[160:163], v[144:147], v[196:199]
    ds_read_b128 v[116:119], v184 offset:16384
    s_add_u32 s69, s69, 98304
    s_cmp_ge_u32 s69, 1966080
    v_mfma_f32_16x16x32_bf16 v[200:203], v[160:163], v[148:151], v[200:203]
    ds_read_b128 v[120:123], v186 offset:16384
    s_cselect_b32 s47, 1966080, 0
    s_sub_u32 s69, s69, s47
    v_mfma_f32_16x16x32_bf16 v[204:207], v[160:163], v[152:155], v[204:207]
    ds_read_b128 v[124:127], v188 offset:16384
    s_add_u32 m0, s70, 0
    s_waitcnt lgkmcnt(3)
    v_mfma_f32_16x16x32_bf16 v[208:211], v[160:163], v[156:159], v[208:211]
    buffer_load_dwordx4 v5, s[60:63], s69 offen offset:0 lds
    v_mfma_f32_16x16x32_bf16 v[212:215], v[164:167], v[144:147], v[212:215]
    ds_read_b128 v[128:131], v190 offset:16384
    s_waitcnt vmcnt(7)
    v_mfma_f32_16x16x32_bf16 v[216:219], v[164:167], v[148:151], v[216:219]
    ds_read_b64_tr_b16 v[172:173], v8 offset:3072
    v_mfma_f32_16x16x32_bf16 v[220:223], v[164:167], v[152:155], v[220:223]
    ds_read_b64_tr_b16 v[174:175], v8 offset:3840
    ds_read_b64_tr_b16 v[176:177], v8 offset:3104
    v_mfma_f32_16x16x32_bf16 v[224:227], v[164:167], v[156:159], v[224:227]
    buffer_load_dwordx4 v6, s[60:63], s69 offen offset:1024 lds
    v_mfma_f32_16x16x32_bf16 v[228:231], v[168:171], v[144:147], v[228:231]
    ds_read_b64_tr_b16 v[178:179], v8 offset:3872
    v_mfma_f32_16x16x32_bf16 v[232:235], v[168:171], v[148:151], v[232:235]
    ds_read_b64_tr_b16 v[180:181], v9 offset:3072
    v_mfma_f32_16x16x32_bf16 v[236:239], v[168:171], v[152:155], v[236:239]
    buffer_load_dwordx4 v7, s[60:63], s69 offen offset:2048 lds
    v_mfma_f32_16x16x32_bf16 v[240:243], v[168:171], v[156:159], v[240:243]
    ds_read_b64_tr_b16 v[182:183], v9 offset:3840
    s_waitcnt lgkmcnt(6)
    v_mfma_f32_16x16x32_bf16 v[196:199], v[132:135], v[116:119], v[196:199]
    ds_read_b128 v[144:147], v185 offset:16384
    s_add_u32 s69, s69, 98304
    v_mfma_f32_16x16x32_bf16 v[200:203], v[132:135], v[120:123], v[200:203]
    ds_read_b128 v[148:151], v187 offset:16384
    v_mfma_f32_16x16x32_bf16 v[204:207], v[132:135], v[124:127], v[204:207]
    ds_read_b128 v[152:155], v189 offset:16384
    s_add_u32 m0, s70, 3072
    s_waitcnt lgkmcnt(3)
    v_mfma_f32_16x16x32_bf16 v[208:211], v[132:135], v[128:131], v[208:211]
    buffer_load_dwordx4 v5, s[60:63], s69 offen offset:0 lds
    v_mfma_f32_16x16x32_bf16 v[212:215], v[136:139], v[116:119], v[212:215]
    ds_read_b128 v[156:159], v191 offset:16384
    s_waitcnt vmcnt(7)
    v_mfma_f32_16x16x32_bf16 v[216:219], v[136:139], v[120:123], v[216:219]
    ds_read_b64_tr_b16 v[160:161], v8 offset:6144
    v_mfma_f32_16x16x32_bf16 v[220:223], v[136:139], v[124:127], v[220:223]
    ds_read_b64_tr_b16 v[162:163], v8 offset:6912
    ds_read_b64_tr_b16 v[164:165], v8 offset:6176
    v_mfma_f32_16x16x32_bf16 v[224:227], v[136:139], v[128:131], v[224:227]
    buffer_load_dwordx4 v6, s[60:63], s69 offen offset:1024 lds
    v_mfma_f32_16x16x32_bf16 v[228:231], v[140:143], v[116:119], v[228:231]
    ds_read_b64_tr_b16 v[166:167], v8 offset:6944
    v_mfma_f32_16x16x32_bf16 v[232:235], v[140:143], v[120:123], v[232:235]
    ds_read_b64_tr_b16 v[168:169], v9 offset:6144
    v_mfma_f32_16x16x32_bf16 v[236:239], v[140:143], v[124:127], v[236:239]
    buffer_load_dwordx4 v7, s[60:63], s69 offen offset:2048 lds
    v_mfma_f32_16x16x32_bf16 v[240:243], v[140:143], v[128:131], v[240:243]
    ds_read_b64_tr_b16 v[170:171], v9 offset:6912
    s_waitcnt lgkmcnt(6)
    v_mfma_f32_16x16x32_bf16 v[196:199], v[172:175], v[144:147], v[196:199]
    ds_read_b128 v[116:119], v184 offset:24576
    s_add_u32 s69, s69, 98304
    s_cmp_ge_u32 s69, 1966080
    v_mfma_f32_16x16x32_bf16 v[200:203], v[172:175], v[148:151], v[200:203]
    ds_read_b128 v[120:123], v186 offset:24576
    s_cselect_b32 s47, 1966080, 0
    s_sub_u32 s69, s69, s47
    v_mfma_f32_16x16x32_bf16 v[204:207], v[172:175], v[152:155], v[204:207]
    ds_read_b128 v[124:127], v188 offset:24576
    s_add_u32 m0, s70, 6144
    s_waitcnt lgkmcnt(3)
    v_mfma_f32_16x16x32_bf16 v[208:211], v[172:175], v[156:159], v[208:211]
    buffer_load_dwordx4 v5, s[60:63], s69 offen offset:0 lds
    v_mfma_f32_16x16x32_bf16 v[212:215], v[176:179], v[144:147], v[212:215]
    ds_read_b128 v[128:131], v190 offset:24576
    s_waitcnt vmcnt(7)
    v_mfma_f32_16x16x32_bf16 v[216:219], v[176:179], v[148:151], v[216:219]
    ds_read_b64_tr_b16 v[132:133], v8 offset:9216
    v_mfma_f32_16x16x32_bf16 v[220:223], v[176:179], v[152:155], v[220:223]
    ds_read_b64_tr_b16 v[134:135], v8 offset:9984
    ds_read_b64_tr_b16 v[136:137], v8 offset:9248
    v_mfma_f32_16x16x32_bf16 v[224:227], v[176:179], v[156:159], v[224:227]
    buffer_load_dwordx4 v6, s[60:63], s69 offen offset:1024 lds
    v_mfma_f32_16x16x32_bf16 v[228:231], v[180:183], v[144:147], v[228:231]
    ds_read_b64_tr_b16 v[138:139], v8 offset:10016
    v_mfma_f32_16x16x32_bf16 v[232:235], v[180:183], v[148:151], v[232:235]
    ds_read_b64_tr_b16 v[140:141], v9 offset:9216
    v_mfma_f32_16x16x32_bf16 v[236:239], v[180:183], v[152:155], v[236:239]
    buffer_load_dwordx4 v7, s[60:63], s69 offen offset:2048 lds
    v_mfma_f32_16x16x32_bf16 v[240:243], v[180:183], v[156:159], v[240:243]
    ds_read_b64_tr_b16 v[142:143], v9 offset:9984
    s_waitcnt lgkmcnt(6)
    v_mfma_f32_16x16x32_bf16 v[196:199], v[160:163], v[116:119], v[196:199]
    ds_read_b128 v[144:147], v185 offset:24576
    s_add_u32 s69, s69, 98304
    v_mfma_f32_16x16x32_bf16 v[200:203], v[160:163], v[120:123], v[200:203]
    ds_read_b128 v[148:151], v187 offset:24576
    v_mfma_f32_16x16x32_bf16 v[204:207], v[160:163], v[124:127], v[204:207]
    ds_read_b128 v[152:155], v189 offset:24576
    s_add_u32 m0, s70, 9216
    s_waitcnt lgkmcnt(3)
    v_mfma_f32_16x16x32_bf16 v[208:211], v[160:163], v[128:131], v[208:211]
    buffer_load_dwordx4 v5, s[60:63], s69 offen offset:0 lds
    v_mfma_f32_16x16x32_bf16 v[212:215], v[164:167], v[116:119], v[212:215]
    ds_read_b128 v[156:159], v191 offset:24576
    s_waitcnt vmcnt(7)
    v_mfma_f32_16x16x32_bf16 v[216:219], v[164:167], v[120:123], v[216:219]
    ds_read_b64_tr_b16 v[172:173], v8 offset:0
    v_mfma_f32_16x16x32_bf16 v[220:223], v[164:167], v[124:127], v[220:223]
    ds_read_b64_tr_b16 v[174:175], v8 offset:768
    ds_read_b64_tr_b16 v[176:177], v8 offset:32
    v_mfma_f32_16x16x32_bf16 v[224:227], v[164:167], v[128:131], v[224:227]
    buffer_load_dwordx4 v6, s[60:63], s69 offen offset:1024 lds
    v_mfma_f32_16x16x32_bf16 v[228:231], v[168:171], v[116:119], v[228:231]
    ds_read_b64_tr_b16 v[178:179], v8 offset:800
    v_mfma_f32_16x16x32_bf16 v[232:235], v[168:171], v[120:123], v[232:235]
    ds_read_b64_tr_b16 v[180:181], v9 offset:0
    v_mfma_f32_16x16x32_bf16 v[236:239], v[168:171], v[124:127], v[236:239]
    buffer_load_dwordx4 v7, s[60:63], s69 offen offset:2048 lds
    v_mfma_f32_16x16x32_bf16 v[240:243], v[168:171], v[128:131], v[240:243]
    ds_read_b64_tr_b16 v[182:183], v9 offset:768
    s_waitcnt lgkmcnt(6)
    v_mfma_f32_16x16x32_bf16 v[196:199], v[132:135], v[144:147], v[196:199]
    ds_read_b128 v[116:119], v184 offset:32768
    s_add_u32 s69, s69, 98304
    s_cmp_ge_u32 s69, 1966080
    v_mfma_f32_16x16x32_bf16 v[200:203], v[132:135], v[148:151], v[200:203]
    ds_read_b128 v[120:123], v186 offset:32768
    s_cselect_b32 s47, 1966080, 0
    s_sub_u32 s69, s69, s47
    v_mfma_f32_16x16x32_bf16 v[204:207], v[132:135], v[152:155], v[204:207]
    ds_read_b128 v[124:127], v188 offset:32768
    s_add_u32 m0, s70, 0
    s_waitcnt lgkmcnt(3)
    v_mfma_f32_16x16x32_bf16 v[208:211], v[132:135], v[156:159], v[208:211]
    buffer_load_dwordx4 v5, s[60:63], s69 offen offset:0 lds
    v_mfma_f32_16x16x32_bf16 v[212:215], v[136:139], v[144:147], v[212:215]
    ds_read_b128 v[128:131], v190 offset:32768
    s_waitcnt vmcnt(7)
    v_mfma_f32_16x16x32_bf16 v[216:219], v[136:139], v[148:151], v[216:219]
    ds_read_b64_tr_b16 v[160:161], v8 offset:3072
    v_mfma_f32_16x16x32_bf16 v[220:223], v[136:139], v[152:155], v[220:223]
    ds_read_b64_tr_b16 v[162:163], v8 offset:3840
    ds_read_b64_tr_b16 v[164:165], v8 offset:3104
    v_mfma_f32_16x16x32_bf16 v[224:227], v[136:139], v[156:159], v[224:227]
    buffer_load_dwordx4 v6, s[60:63], s69 offen offset:1024 lds
    v_mfma_f32_16x16x32_bf16 v[228:231], v[140:143], v[144:147], v[228:231]
    ds_read_b64_tr_b16 v[166:167], v8 offset:3872
    v_mfma_f32_16x16x32_bf16 v[232:235], v[140:143], v[148:151], v[232:235]
    ds_read_b64_tr_b16 v[168:169], v9 offset:3072
    v_mfma_f32_16x16x32_bf16 v[236:239], v[140:143], v[152:155], v[236:239]
    buffer_load_dwordx4 v7, s[60:63], s69 offen offset:2048 lds
    v_mfma_f32_16x16x32_bf16 v[240:243], v[140:143], v[156:159], v[240:243]
    ds_read_b64_tr_b16 v[170:171], v9 offset:3840
    s_waitcnt lgkmcnt(6)
    v_mfma_f32_16x16x32_bf16 v[196:199], v[172:175], v[116:119], v[196:199]
    ds_read_b128 v[144:147], v185 offset:32768
    s_add_u32 s69, s69, 98304
    v_mfma_f32_16x16x32_bf16 v[200:203], v[172:175], v[120:123], v[200:203]
    ds_read_b128 v[148:151], v187 offset:32768
    v_mfma_f32_16x16x32_bf16 v[204:207], v[172:175], v[124:127], v[204:207]
    ds_read_b128 v[152:155], v189 offset:32768
    s_add_u32 m0, s70, 3072
    s_waitcnt lgkmcnt(3)
    v_mfma_f32_16x16x32_bf16 v[208:211], v[172:175], v[128:131], v[208:211]
    buffer_load_dwordx4 v5, s[60:63], s69 offen offset:0 lds
    v_mfma_f32_16x16x32_bf16 v[212:215], v[176:179], v[116:119], v[212:215]
    ds_read_b128 v[156:159], v191 offset:32768
    s_waitcnt vmcnt(7)
    v_mfma_f32_16x16x32_bf16 v[216:219], v[176:179], v[120:123], v[216:219]
    ds_read_b64_tr_b16 v[132:133], v8 offset:6144
    v_mfma_f32_16x16x32_bf16 v[220:223], v[176:179], v[124:127], v[220:223]
    ds_read_b64_tr_b16 v[134:135], v8 offset:6912
    ds_read_b64_tr_b16 v[136:137], v8 offset:6176
    v_mfma_f32_16x16x32_bf16 v[224:227], v[176:179], v[128:131], v[224:227]
    buffer_load_dwordx4 v6, s[60:63], s69 offen offset:1024 lds
    v_mfma_f32_16x16x32_bf16 v[228:231], v[180:183], v[116:119], v[228:231]
    ds_read_b64_tr_b16 v[138:139], v8 offset:6944
    v_mfma_f32_16x16x32_bf16 v[232:235], v[180:183], v[120:123], v[232:235]
    ds_read_b64_tr_b16 v[140:141], v9 offset:6144
    v_mfma_f32_16x16x32_bf16 v[236:239], v[180:183], v[124:127], v[236:239]
    buffer_load_dwordx4 v7, s[60:63], s69 offen offset:2048 lds
    v_mfma_f32_16x16x32_bf16 v[240:243], v[180:183], v[128:131], v[240:243]
    ds_read_b64_tr_b16 v[142:143], v9 offset:6912
    s_waitcnt lgkmcnt(6)
    v_mfma_f32_16x16x32_bf16 v[196:199], v[160:163], v[144:147], v[196:199]
    ds_read_b128 v[116:119], v184 offset:40960
    s_add_u32 s69, s69, 98304
    s_cmp_ge_u32 s69, 1966080
    v_mfma_f32_16x16x32_bf16 v[200:203], v[160:163], v[148:151], v[200:203]
    ds_read_b128 v[120:123], v186 offset:40960
    s_cselect_b32 s47, 1966080, 0
    s_sub_u32 s69, s69, s47
    v_mfma_f32_16x16x32_bf16 v[204:207], v[160:163], v[152:155], v[204:207]
    ds_read_b128 v[124:127], v188 offset:40960
    s_add_u32 m0, s70, 6144
    s_waitcnt lgkmcnt(3)
    v_mfma_f32_16x16x32_bf16 v[208:211], v[160:163], v[156:159], v[208:211]
    buffer_load_dwordx4 v5, s[60:63], s69 offen offset:0 lds
    v_mfma_f32_16x16x32_bf16 v[212:215], v[164:167], v[144:147], v[212:215]
    ds_read_b128 v[128:131], v190 offset:40960
    s_waitcnt vmcnt(7)
    v_mfma_f32_16x16x32_bf16 v[216:219], v[164:167], v[148:151], v[216:219]
    ds_read_b64_tr_b16 v[172:173], v8 offset:9216
    v_mfma_f32_16x16x32_bf16 v[220:223], v[164:167], v[152:155], v[220:223]
    ds_read_b64_tr_b16 v[174:175], v8 offset:9984
    ds_read_b64_tr_b16 v[176:177], v8 offset:9248
    v_mfma_f32_16x16x32_bf16 v[224:227], v[164:167], v[156:159], v[224:227]
    buffer_load_dwordx4 v6, s[60:63], s69 offen offset:1024 lds
    v_mfma_f32_16x16x32_bf16 v[228:231], v[168:171], v[144:147], v[228:231]
    ds_read_b64_tr_b16 v[178:179], v8 offset:10016
    v_mfma_f32_16x16x32_bf16 v[232:235], v[168:171], v[148:151], v[232:235]
    ds_read_b64_tr_b16 v[180:181], v9 offset:9216
    v_mfma_f32_16x16x32_bf16 v[236:239], v[168:171], v[152:155], v[236:239]
    buffer_load_dwordx4 v7, s[60:63], s69 offen offset:2048 lds
    v_mfma_f32_16x16x32_bf16 v[240:243], v[168:171], v[156:159], v[240:243]
    ds_read_b64_tr_b16 v[182:183], v9 offset:9984
    s_waitcnt lgkmcnt(6)
    v_mfma_f32_16x16x32_bf16 v[196:199], v[132:135], v[116:119], v[196:199]
    ds_read_b128 v[144:147], v185 offset:40960
    s_add_u32 s69, s69, 98304
    v_mfma_f32_16x16x32_bf16 v[200:203], v[132:135], v[120:123], v[200:203]
    ds_read_b128 v[148:151], v187 offset:40960
    v_mfma_f32_16x16x32_bf16 v[204:207], v[132:135], v[124:127], v[204:207]
    ds_read_b128 v[152:155], v189 offset:40960
    s_add_u32 m0, s70, 9216
    s_waitcnt lgkmcnt(3)
    v_mfma_f32_16x16x32_bf16 v[208:211], v[132:135], v[128:131], v[208:211]
    buffer_load_dwordx4 v5, s[60:63], s69 offen offset:0 lds
    v_mfma_f32_16x16x32_bf16 v[212:215], v[136:139], v[116:119], v[212:215]
    ds_read_b128 v[156:159], v191 offset:40960
    s_waitcnt vmcnt(7)
    v_mfma_f32_16x16x32_bf16 v[216:219], v[136:139], v[120:123], v[216:219]
    ds_read_b64_tr_b16 v[160:161], v8 offset:0
    v_mfma_f32_16x16x32_bf16 v[220:223], v[136:139], v[124:127], v[220:223]
    ds_read_b64_tr_b16 v[162:163], v8 offset:768
    ds_read_b64_tr_b16 v[164:165], v8 offset:32
    v_mfma_f32_16x16x32_bf16 v[224:227], v[136:139], v[128:131], v[224:227]
    buffer_load_dwordx4 v6, s[60:63], s69 offen offset:1024 lds
    v_mfma_f32_16x16x32_bf16 v[228:231], v[140:143], v[116:119], v[228:231]
    ds_read_b64_tr_b16 v[166:167], v8 offset:800
    v_mfma_f32_16x16x32_bf16 v[232:235], v[140:143], v[120:123], v[232:235]
    ds_read_b64_tr_b16 v[168:169], v9 offset:0
    v_mfma_f32_16x16x32_bf16 v[236:239], v[140:143], v[124:127], v[236:239]
    buffer_load_dwordx4 v7, s[60:63], s69 offen offset:2048 lds
    v_mfma_f32_16x16x32_bf16 v[240:243], v[140:143], v[128:131], v[240:243]
    ds_read_b64_tr_b16 v[170:171], v9 offset:768
    s_waitcnt lgkmcnt(6)
    v_mfma_f32_16x16x32_bf16 v[196:199], v[172:175], v[144:147], v[196:199]
    ds_read_b128 v[116:119], v184 offset:49152
    s_add_u32 s69, s69, 98304
    s_cmp_ge_u32 s69, 1966080
    v_mfma_f32_16x16x32_bf16 v[200:203], v[172:175], v[148:151], v[200:203]
    ds_read_b128 v[120:123], v186 offset:49152
    s_cselect_b32 s47, 1966080, 0
    s_sub_u32 s69, s69, s47
    v_mfma_f32_16x16x32_bf16 v[204:207], v[172:175], v[152:155], v[204:207]
    ds_read_b128 v[124:127], v188 offset:49152
    s_add_u32 m0, s70, 0
    s_waitcnt lgkmcnt(3)
    v_mfma_f32_16x16x32_bf16 v[208:211], v[172:175], v[156:159], v[208:211]
    buffer_load_dwordx4 v5, s[60:63], s69 offen offset:0 lds
    v_mfma_f32_16x16x32_bf16 v[212:215], v[176:179], v[144:147], v[212:215]
    ds_read_b128 v[128:131], v190 offset:49152
    s_waitcnt vmcnt(7)
    v_mfma_f32_16x16x32_bf16 v[216:219], v[176:179], v[148:151], v[216:219]
    ds_read_b64_tr_b16 v[132:133], v8 offset:3072
    v_mfma_f32_16x16x32_bf16 v[220:223], v[176:179], v[152:155], v[220:223]
    ds_read_b64_tr_b16 v[134:135], v8 offset:3840
    ds_read_b64_tr_b16 v[136:137], v8 offset:3104
    v_mfma_f32_16x16x32_bf16 v[224:227], v[176:179], v[156:159], v[224:227]
    buffer_load_dwordx4 v6, s[60:63], s69 offen offset:1024 lds
    v_mfma_f32_16x16x32_bf16 v[228:231], v[180:183], v[144:147], v[228:231]
    ds_read_b64_tr_b16 v[138:139], v8 offset:3872
    v_mfma_f32_16x16x32_bf16 v[232:235], v[180:183], v[148:151], v[232:235]
    ds_read_b64_tr_b16 v[140:141], v9 offset:3072
    v_mfma_f32_16x16x32_bf16 v[236:239], v[180:183], v[152:155], v[236:239]
    buffer_load_dwordx4 v7, s[60:63], s69 offen offset:2048 lds
    v_mfma_f32_16x16x32_bf16 v[240:243], v[180:183], v[156:159], v[240:243]
    ds_read_b64_tr_b16 v[142:143], v9 offset:3840
    s_waitcnt lgkmcnt(6)
    v_mfma_f32_16x16x32_bf16 v[196:199], v[160:163], v[116:119], v[196:199]
    ds_read_b128 v[144:147], v185 offset:49152
    s_add_u32 s69, s69, 98304
    v_mfma_f32_16x16x32_bf16 v[200:203], v[160:163], v[120:123], v[200:203]
    ds_read_b128 v[148:151], v187 offset:49152
    v_mfma_f32_16x16x32_bf16 v[204:207], v[160:163], v[124:127], v[204:207]
    ds_read_b128 v[152:155], v189 offset:49152
    s_add_u32 m0, s70, 3072
    s_waitcnt lgkmcnt(3)
    v_mfma_f32_16x16x32_bf16 v[208:211], v[160:163], v[128:131], v[208:211]
    buffer_load_dwordx4 v5, s[60:63], s69 offen offset:0 lds
    v_mfma_f32_16x16x32_bf16 v[212:215], v[164:167], v[116:119], v[212:215]
    ds_read_b128 v[156:159], v191 offset:49152
    s_waitcnt vmcnt(7)
    v_mfma_f32_16x16x32_bf16 v[216:219], v[164:167], v[120:123], v[216:219]
    ds_read_b64_tr_b16 v[172:173], v8 offset:6144
    v_mfma_f32_16x16x32_bf16 v[220:223], v[164:167], v[124:127], v[220:223]
    ds_read_b64_tr_b16 v[174:175], v8 offset:6912
    ds_read_b64_tr_b16 v[176:177], v8 offset:6176
    v_mfma_f32_16x16x32_bf16 v[224:227], v[164:167], v[128:131], v[224:227]
    buffer_load_dwordx4 v6, s[60:63], s69 offen offset:1024 lds
    v_mfma_f32_16x16x32_bf16 v[228:231], v[168:171], v[116:119], v[228:231]
    ds_read_b64_tr_b16 v[178:179], v8 offset:6944
    v_mfma_f32_16x16x32_bf16 v[232:235], v[168:171], v[120:123], v[232:235]
    ds_read_b64_tr_b16 v[180:181], v9 offset:6144
    v_mfma_f32_16x16x32_bf16 v[236:239], v[168:171], v[124:127], v[236:239]
    buffer_load_dwordx4 v7, s[60:63], s69 offen offset:2048 lds
    v_mfma_f32_16x16x32_bf16 v[240:243], v[168:171], v[128:131], v[240:243]
    ds_read_b64_tr_b16 v[182:183], v9 offset:6912
    s_waitcnt lgkmcnt(6)
    v_mfma_f32_16x16x32_bf16 v[196:199], v[132:135], v[144:147], v[196:199]
    ds_read_b128 v[116:119], v184 offset:57344
    s_add_u32 s69, s69, 98304
    s_cmp_ge_u32 s69, 1966080
    v_mfma_f32_16x16x32_bf16 v[200:203], v[132:135], v[148:151], v[200:203]
    ds_read_b128 v[120:123], v186 offset:57344
    s_cselect_b32 s47, 1966080, 0
    s_sub_u32 s69, s69, s47
    v_mfma_f32_16x16x32_bf16 v[204:207], v[132:135], v[152:155], v[204:207]
    ds_read_b128 v[124:127], v188 offset:57344
    s_add_u32 m0, s70, 6144
    s_waitcnt lgkmcnt(3)
    v_mfma_f32_16x16x32_bf16 v[208:211], v[132:135], v[156:159], v[208:211]
    buffer_load_dwordx4 v5, s[60:63], s69 offen offset:0 lds
    v_mfma_f32_16x16x32_bf16 v[212:215], v[136:139], v[144:147], v[212:215]
    ds_read_b128 v[128:131], v190 offset:57344
    s_waitcnt vmcnt(7)
    v_mfma_f32_16x16x32_bf16 v[216:219], v[136:139], v[148:151], v[216:219]
    ds_read_b64_tr_b16 v[160:161], v8 offset:9216
    v_mfma_f32_16x16x32_bf16 v[220:223], v[136:139], v[152:155], v[220:223]
    ds_read_b64_tr_b16 v[162:163], v8 offset:9984
    ds_read_b64_tr_b16 v[164:165], v8 offset:9248
    v_mfma_f32_16x16x32_bf16 v[224:227], v[136:139], v[156:159], v[224:227]
    buffer_load_dwordx4 v6, s[60:63], s69 offen offset:1024 lds
    v_mfma_f32_16x16x32_bf16 v[228:231], v[140:143], v[144:147], v[228:231]
    ds_read_b64_tr_b16 v[166:167], v8 offset:10016
    v_mfma_f32_16x16x32_bf16 v[232:235], v[140:143], v[148:151], v[232:235]
    ds_read_b64_tr_b16 v[168:169], v9 offset:9216
    v_mfma_f32_16x16x32_bf16 v[236:239], v[140:143], v[152:155], v[236:239]
    buffer_load_dwordx4 v7, s[60:63], s69 offen offset:2048 lds
    v_mfma_f32_16x16x32_bf16 v[240:243], v[140:143], v[156:159], v[240:243]
    ds_read_b64_tr_b16 v[170:171], v9 offset:9984
    s_waitcnt lgkmcnt(6)
    v_mfma_f32_16x16x32_bf16 v[196:199], v[172:175], v[116:119], v[196:199]
    ds_read_b128 v[144:147], v185 offset:57344
    s_add_u32 s69, s69, 98304
    v_mfma_f32_16x16x32_bf16 v[200:203], v[172:175], v[120:123], v[200:203]
    ds_read_b128 v[148:151], v187 offset:57344
    v_mfma_f32_16x16x32_bf16 v[204:207], v[172:175], v[124:127], v[204:207]
    ds_read_b128 v[152:155], v189 offset:57344
    s_add_u32 m0, s70, 9216
    s_waitcnt lgkmcnt(3)
    v_mfma_f32_16x16x32_bf16 v[208:211], v[172:175], v[128:131], v[208:211]
    buffer_load_dwordx4 v5, s[60:63], s69 offen offset:0 lds
    v_mfma_f32_16x16x32_bf16 v[212:215], v[176:179], v[116:119], v[212:215]
    ds_read_b128 v[156:159], v191 offset:57344
    s_waitcnt vmcnt(7)
    v_mfma_f32_16x16x32_bf16 v[216:219], v[176:179], v[120:123], v[216:219]
    ds_read_b64_tr_b16 v[132:133], v8 offset:0
    v_add_u32 v184, 0x10000, v184
    v_mfma_f32_16x16x32_bf16 v[220:223], v[176:179], v[124:127], v[220:223]
    ds_read_b64_tr_b16 v[134:135], v8 offset:768
    ds_read_b64_tr_b16 v[136:137], v8 offset:32
    v_mfma_f32_16x16x32_bf16 v[224:227], v[176:179], v[128:131], v[224:227]
    buffer_load_dwordx4 v6, s[60:63], s69 offen offset:1024 lds
    v_mfma_f32_16x16x32_bf16 v[228:231], v[180:183], v[116:119], v[228:231]
    ds_read_b64_tr_b16 v[138:139], v8 offset:800
    v_add_u32 v186, 0x10000, v186
    ds_read_b32 v11, v10 offset:16
    v_mfma_f32_16x16x32_bf16 v[232:235], v[180:183], v[120:123], v[232:235]
    ds_read_b64_tr_b16 v[140:141], v9 offset:0
    v_add_u32 v188, 0x10000, v188
    v_add_u32 v190, 0x10000, v190
    v_mfma_f32_16x16x32_bf16 v[236:239], v[180:183], v[124:127], v[236:239]
    buffer_load_dwordx4 v7, s[60:63], s69 offen offset:2048 lds
    v_mfma_f32_16x16x32_bf16 v[240:243], v[180:183], v[128:131], v[240:243]
    ds_read_b64_tr_b16 v[142:143], v9 offset:768
    s_waitcnt lgkmcnt(0)
    v_mfma_f32_16x16x32_bf16 v[196:199], v[160:163], v[144:147], v[196:199]
    v_readfirstlane_b32 s44, v11
    s_nop 0
    s_cmp_ge_u32 s44, 1
    s_cbranch_scc1 L_ok_5
    s_waitcnt lgkmcnt(0)
    s_mov_b32 s48, 0
    s_nop 1
L_spin_6:
    ds_read_b32 v11, v10 offset:16
    s_add_u32 s48, s48, 1
    s_waitcnt lgkmcnt(0)
    v_readfirstlane_b32 s44, v11
    s_nop 0
    s_cmp_ge_u32 s44, 1
    s_cbranch_scc1 L_spun_7
    s_cmp_lt_u32 s48, 400000
    s_cbranch_scc1 L_spin_6
L_spun_7:
L_ok_5:
    ds_read_b128 v[116:119], v184 offset:0
    s_add_u32 s69, s69, 98304
    s_cmp_ge_u32 s69, 1966080
    v_mfma_f32_16x16x32_bf16 v[200:203], v[160:163], v[148:151], v[200:203]
    ds_read_b128 v[120:123], v186 offset:0
    s_cselect_b32 s47, 1966080, 0
    s_sub_u32 s69, s69, s47
    v_mfma_f32_16x16x32_bf16 v[204:207], v[160:163], v[152:155], v[204:207]
    ds_read_b128 v[124:127], v188 offset:0
    v_mfma_f32_16x16x32_bf16 v[208:211], v[160:163], v[156:159], v[208:211]
    buffer_load_dwordx4 v[16:19], v2, s[52:55], s16 offen offset:0 sc1
    v_mfma_f32_16x16x32_bf16 v[212:215], v[164:167], v[144:147], v[212:215]
    ds_read_b128 v[128:131], v190 offset:0
    s_waitcnt vmcnt(7)
    v_mfma_f32_16x16x32_bf16 v[216:219], v[164:167], v[148:151], v[216:219]
    ds_read_b64_tr_b16 v[172:173], v8 offset:3072
    v_add_u32 v185, 0x10000, v185
    v_mfma_f32_16x16x32_bf16 v[220:223], v[164:167], v[152:155], v[220:223]
    ds_read_b64_tr_b16 v[174:175], v8 offset:3840
    ds_read_b64_tr_b16 v[176:177], v8 offset:3104
    v_mfma_f32_16x16x32_bf16 v[224:227], v[164:167], v[156:159], v[224:227]
    buffer_load_dwordx4 v[20:23], v2, s[52:55], s16 offen offset:1024 sc1
    v_mfma_f32_16x16x32_bf16 v[228:231], v[168:171], v[144:147], v[228:231]
    ds_read_b64_tr_b16 v[178:179], v8 offset:3872
    v_add_u32 v187, 0x10000, v187
    v_mfma_f32_16x16x32_bf16 v[232:235], v[168:171], v[148:151], v[232:235]
    ds_read_b64_tr_b16 v[180:181], v9 offset:3072
    v_add_u32 v189, 0x10000, v189
    v_add_u32 v191, 0x10000, v191
    v_mfma_f32_16x16x32_bf16 v[236:239], v[168:171], v[152:155], v[236:239]
    buffer_load_dwordx4 v[24:27], v2, s[52:55], s16 offen offset:2048 sc1
    v_mfma_f32_16x16x32_bf16 v[240:243], v[168:171], v[156:159], v[240:243]
    ds_read_b64_tr_b16 v[182:183], v9 offset:3840
    s_waitcnt lgkmcnt(6)
    v_mfma_f32_16x16x32_bf16 v[196:199], v[132:135], v[116:119], v[196:199]
    ds_read_b128 v[144:147], v185 offset:0
    v_mfma_f32_16x16x32_bf16 v[200:203], v[132:135], v[120:123], v[200:203]
    ds_read_b128 v[148:151], v187 offset:0
    v_mfma_f32_16x16x32_bf16 v[204:207], v[132:135], v[124:127], v[204:207]
    ds_read_b128 v[152:155], v189 offset:0
    v_mfma_f32_16x16x32_bf16 v[208:211], v[132:135], v[128:131], v[208:211]
    buffer_load_dwordx4 v[28:31], v2, s[52:55], s16 offen offset:3072 sc1
    v_mfma_f32_16x16x32_bf16 v[212:215], v[136:139], v[116:119], v[212:215]
    ds_read_b128 v[156:159], v191 offset:0
    s_waitcnt vmcnt(7)
    v_mfma_f32_16x16x32_bf16 v[216:219], v[136:139], v[120:123], v[216:219]
    ds_read_b64_tr_b16 v[160:161], v8 offset:6144
    v_mfma_f32_16x16x32_bf16 v[220:223], v[136:139], v[124:127], v[220:223]
    ds_read_b64_tr_b16 v[162:163], v8 offset:6912
    ds_read_b64_tr_b16 v[164:165], v8 offset:6176
    v_mfma_f32_16x16x32_bf16 v[224:227], v[136:139], v[128:131], v[224:227]
    buffer_load_dwordx4 v[32:35], v15, s[52:55], s16 offen sc1
    v_mfma_f32_16x16x32_bf16 v[228:231], v[140:143], v[116:119], v[228:231]
    ds_read_b64_tr_b16 v[166:167], v8 offset:6944
    s_add_u32 s16, s16, 5120
    v_mfma_f32_16x16x32_bf16 v[232:235], v[140:143], v[120:123], v[232:235]
    ds_read_b64_tr_b16 v[168:169], v9 offset:6144
    v_mfma_f32_16x16x32_bf16 v[236:239], v[140:143], v[124:127], v[236:239]
    buffer_load_dwordx4 v[36:39], v2, s[52:55], s16 offen offset:0 sc1
    v_mfma_f32_16x16x32_bf16 v[240:243], v[140:143], v[128:131], v[240:243]
    ds_read_b64_tr_b16 v[170:171], v9 offset:6912
    s_waitcnt lgkmcnt(6)
    v_mfma_f32_16x16x32_bf16 v[196:199], v[172:175], v[144:147], v[196:199]
    ds_read_b128 v[116:119], v184 offset:8192
    v_mfma_f32_16x16x32_bf16 v[200:203], v[172:175], v[148:151], v[200:203]
    ds_read_b128 v[120:123], v186 offset:8192
    v_mfma_f32_16x16x32_bf16 v[204:207], v[172:175], v[152:155], v[204:207]
    ds_read_b128 v[124:127], v188 offset:8192
    v_mfma_f32_16x16x32_bf16 v[208:211], v[172:175], v[156:159], v[208:211]
    buffer_load_dwordx4 v[40:43], v2, s[52:55], s16 offen offset:1024 sc1
    v_mfma_f32_16x16x32_bf16 v[212:215], v[176:179], v[144:147], v[212:215]
    ds_read_b128 v[128:131], v190 offset:8192
    s_waitcnt vmcnt(7)
    v_mfma_f32_16x16x32_bf16 v[216:219], v[176:179], v[148:151], v[216:219]
    ds_read_b64_tr_b16 v[132:133], v8 offset:9216
    v_mfma_f32_16x16x32_bf16 v[220:223], v[176:179], v[152:155], v[220:223]
    ds_read_b64_tr_b16 v[134:135], v8 offset:9984
    ds_read_b64_tr_b16 v[136:137], v8 offset:9248
    v_mfma_f32_16x16x32_bf16 v[224:227], v[176:179], v[156:159], v[224:227]
    buffer_load_dwordx4 v[44:47], v2, s[52:55], s16 offen offset:2048 sc1
    v_mfma_f32_16x16x32_bf16 v[228:231], v[180:183], v[144:147], v[228:231]
    ds_read_b64_tr_b16 v[138:139], v8 offset:10016
    v_mfma_f32_16x16x32_bf16 v[232:235], v[180:183], v[148:151], v[232:235]
    ds_read_b64_tr_b16 v[140:141], v9 offset:9216
    v_mfma_f32_16x16x32_bf16 v[236:239], v[180:183], v[152:155], v[236:239]
    buffer_load_dwordx4 v[48:51], v2, s[52:55], s16 offen offset:3072 sc1
    v_mfma_f32_16x16x32_bf16 v[240:243], v[180:183], v[156:159], v[240:243]
    ds_read_b64_tr_b16 v[142:143], v9 offset:9984
    s_waitcnt lgkmcnt(6)
    v_mfma_f32_16x16x32_bf16 v[196:199], v[160:163], v[116:119], v[196:199]
    ds_read_b128 v[144:147], v185 offset:8192
    v_mfma_f32_16x16x32_bf16 v[200:203], v[160:163], v[120:123], v[200:203]
    ds_read_b128 v[148:151], v187 offset:8192
    v_mfma_f32_16x16x32_bf16 v[204:207], v[160:163], v[124:127], v[204:207]
    ds_read_b128 v[152:155], v189 offset:8192
    v_mfma_f32_16x16x32_bf16 v[208:211], v[160:163], v[128:131], v[208:211]
    buffer_load_dwordx4 v[52:55], v15, s[52:55], s16 offen sc1
    v_mfma_f32_16x16x32_bf16 v[212:215], v[164:167], v[116:119], v[212:215]
    ds_read_b128 v[156:159], v191 offset:8192
    s_add_u32 s16, s16, 5120
    v_mfma_f32_16x16x32_bf16 v[216:219], v[164:167], v[120:123], v[216:219]
    v_mfma_f32_16x16x32_bf16 v[220:223], v[164:167], v[124:127], v[220:223]
    v_mfma_f32_16x16x32_bf16 v[224:227], v[164:167], v[128:131], v[224:227]
    buffer_load_dwordx4 v[56:59], v2, s[52:55], s16 offen offset:0 sc1
    v_mfma_f32_16x16x32_bf16 v[228:231], v[168:171], v[116:119], v[228:231]
    v_mfma_f32_16x16x32_bf16 v[232:235], v[168:171], v[120:123], v[232:235]
    v_mfma_f32_16x16x32_bf16 v[236:239], v[168:171], v[124:127], v[236:239]
    buffer_load_dwordx4 v[60:63], v2, s[52:55], s16 offen offset:1024 sc1
    v_mfma_f32_16x16x32_bf16 v[240:243], v[168:171], v[128:131], v[240:243]
    s_waitcnt lgkmcnt(0)
    v_mfma_f32_16x16x32_bf16 v[196:199], v[132:135], v[144:147], v[196:199]
    v_mfma_f32_16x16x32_bf16 v[212:215], v[136:139], v[144:147], v[212:215]
    v_mfma_f32_16x16x32_bf16 v[200:203], v[132:135], v[148:151], v[200:203]
    v_mfma_f32_16x16x32_bf16 v[216:219], v[136:139], v[148:151], v[216:219]
    buffer_load_dwordx4 v[64:67], v2, s[52:55], s16 offen offset:2048 sc1
    v_mfma_f32_16x16x32_bf16 v[204:207], v[132:135], v[152:155], v[204:207]
    v_mfma_f32_16x16x32_bf16 v[220:223], v[136:139], v[152:155], v[220:223]
    v_mfma_f32_16x16x32_bf16 v[208:211], v[132:135], v[156:159], v[208:211]
    v_mfma_f32_16x16x32_bf16 v[224:227], v[136:139], v[156:159], v[224:227]
    buffer_load_dwordx4 v[68:71], v2, s[52:55], s16 offen offset:3072 sc1
    v_mfma_f32_16x16x32_bf16 v[228:231], v[140:143], v[144:147], v[228:231]
    v_mfma_f32_16x16x32_bf16 v[232:235], v[140:143], v[148:151], v[232:235]
    v_mfma_f32_16x16x32_bf16 v[236:239], v[140:143], v[152:155], v[236:239]
    buffer_load_dwordx4 v[72:75], v15, s[52:55], s16 offen sc1
    v_mfma_f32_16x16x32_bf16 v[240:243], v[140:143], v[156:159], v[240:243]
    s_add_u32 s16, s16, 5120
    v_mul_f32_e64 v196, v196, abs(v196)
    v_mul_f32_e64 v197, v197, abs(v197)
    v_mul_f32_e64 v198, v198, abs(v198)
    v_mul_f32_e64 v199, v199, abs(v199)
    v_cvt_pk_bf16_f32 v116, v196, v197
    v_cvt_pk_bf16_f32 v117, v198, v199
    v_pk_max_i16 v116, v116, 0
    v_pk_max_i16 v117, v117, 0
    v_mul_f32_e64 v212, v212, abs(v212)
    v_mul_f32_e64 v213, v213, abs(v213)
    v_mul_f32_e64 v214, v214, abs(v214)
    v_mul_f32_e64 v215, v215, abs(v215)
    v_cvt_pk_bf16_f32 v118, v212, v213
    v_cvt_pk_bf16_f32 v119, v214, v215
    v_pk_max_i16 v118, v118, 0
    v_pk_max_i16 v119, v119, 0
    buffer_store_dwordx4 v[116:119], v2, s[52:55], s73 offen sc1
    v_mul_f32_e64 v200, v200, abs(v200)
    v_mul_f32_e64 v201, v201, abs(v201)
    v_mul_f32_e64 v202, v202, abs(v202)
    v_mul_f32_e64 v203, v203, abs(v203)
    v_cvt_pk_bf16_f32 v120, v200, v201
    v_cvt_pk_bf16_f32 v121, v202, v203
    v_pk_max_i16 v120, v120, 0
    v_pk_max_i16 v121, v121, 0
    v_mul_f32_e64 v216, v216, abs(v216)
    v_mul_f32_e64 v217, v217, abs(v217)
    v_mul_f32_e64 v218, v218, abs(v218)
    v_mul_f32_e64 v219, v219, abs(v219)
    v_cvt_pk_bf16_f32 v122, v216, v217
    v_cvt_pk_bf16_f32 v123, v218, v219
    v_pk_max_i16 v122, v122, 0
    v_pk_max_i16 v123, v123, 0
    buffer_store_dwordx4 v[120:123], v2, s[52:55], s74 offen sc1
    v_mul_f32_e64 v204, v204, abs(v204)
    v_mul_f32_e64 v205, v205, abs(v205)
    v_mul_f32_e64 v206, v206, abs(v206)
    v_mul_f32_e64 v207, v207, abs(v207)
    v_cvt_pk_bf16_f32 v124, v204, v205
    v_cvt_pk_bf16_f32 v125, v206, v207
    v_pk_max_i16 v124, v124, 0
    v_pk_max_i16 v125, v125, 0
    v_mul_f32_e64 v220, v220, abs(v220)
    v_mul_f32_e64 v221, v221, abs(v221)
    v_mul_f32_e64 v222, v222, abs(v222)
    v_mul_f32_e64 v223, v223, abs(v223)
    v_cvt_pk_bf16_f32 v126, v220, v221
    v_cvt_pk_bf16_f32 v127, v222, v223
    v_pk_max_i16 v126, v126, 0
    v_pk_max_i16 v127, v127, 0
    buffer_store_dwordx4 v[124:127], v2, s[52:55], s75 offen sc1
    v_mul_f32_e64 v208, v208, abs(v208)
    v_mul_f32_e64 v209, v209, abs(v209)
    v_mul_f32_e64 v210, v210, abs(v210)
    v_mul_f32_e64 v211, v211, abs(v211)
    v_cvt_pk_bf16_f32 v128, v208, v209
    v_cvt_pk_bf16_f32 v129, v210, v211
    v_pk_max_i16 v128, v128, 0
    v_pk_max_i16 v129, v129, 0
    v_mul_f32_e64 v224, v224, abs(v224)
    v_mul_f32_e64 v225, v225, abs(v225)
    v_mul_f32_e64 v226, v226, abs(v226)
    v_mul_f32_e64 v227, v227, abs(v227)
    v_cvt_pk_bf16_f32 v130, v224, v225
    v_cvt_pk_bf16_f32 v131, v226, v227
    v_pk_max_i16 v130, v130, 0
    v_pk_max_i16 v131, v131, 0
    buffer_store_dwordx4 v[128:131], v2, s[52:55], s76 offen sc1
    v_mul_f32_e64 v228, v228, abs(v228)
    v_mul_f32_e64 v229, v229, abs(v229)
    v_mul_f32_e64 v230, v230, abs(v230)
    v_mul_f32_e64 v231, v231, abs(v231)
    v_cvt_pk_bf16_f32 v132, v228, v229
    v_cvt_pk_bf16_f32 v133, v230, v231
    v_pk_max_i16 v132, v132, 0
    v_pk_max_i16 v133, v133, 0
    v_mul_f32_e64 v232, v232, abs(v232)
    v_mul_f32_e64 v233, v233, abs(v233)
    v_mul_f32_e64 v234, v234, abs(v234)
    v_mul_f32_e64 v235, v235, abs(v235)
    v_cvt_pk_bf16_f32 v134, v232, v233
    v_cvt_pk_bf16_f32 v135, v234, v235
    v_pk_max_i16 v134, v134, 0
    v_pk_max_i16 v135, v135, 0
    buffer_store_dwordx4 v[132:135], v2, s[52:55], s77 offen sc1
    v_mul_f32_e64 v236, v236, abs(v236)
    v_mul_f32_e64 v237, v237, abs(v237)
    v_mul_f32_e64 v238, v238, abs(v238)
    v_mul_f32_e64 v239, v239, abs(v239)
    v_cvt_pk_bf16_f32 v136, v236, v237
    v_cvt_pk_bf16_f32 v137, v238, v239
    v_pk_max_i16 v136, v136, 0
    v_pk_max_i16 v137, v137, 0
    v_mul_f32_e64 v240, v240, abs(v240)
    v_mul_f32_e64 v241, v241, abs(v241)
    v_mul_f32_e64 v242, v242, abs(v242)
    v_mul_f32_e64 v243, v243, abs(v243)
    v_cvt_pk_bf16_f32 v138, v240, v241
    v_cvt_pk_bf16_f32 v139, v242, v243
    v_pk_max_i16 v138, v138, 0
    v_pk_max_i16 v139, v139, 0
    buffer_store_dwordx4 v[136:139], v2, s[52:55], s78 offen sc1
    s_mov_b64 exec, 1
    ds_add_u32 v10, v0 offset:8
    s_mov_b64 exec, -1
    buffer_load_dwordx4 v[76:79], v2, s[52:55], s17 offen offset:0 sc1
    v_lshrrev_b32 v13, 4, v1
    v_lshlrev_b32 v184, 4, v13
    v_add_u32 v184, 159744, v184
    ds_read_b128 v[196:199], v194 offset:0
    ds_read_b128 v[200:203], v184 offset:0
    ds_read_b128 v[204:207], v195 offset:0
    ds_read_b128 v[208:211], v184 offset:64
    ds_read_b128 v[212:215], v194 offset:8192
    ds_read_b128 v[216:219], v184 offset:128
    ds_read_b128 v[220:223], v195 offset:8192
    ds_read_b128 v[224:227], v184 offset:192
    ds_read_b128 v[228:231], v194 offset:16384
    ds_read_b128 v[232:235], v184 offset:256
    buffer_load_dwordx4 v[80:83], v2, s[52:55], s17 offen offset:1024 sc1
    ds_read_b128 v[144:147], v195 offset:16384
    ds_read_b128 v[148:151], v184 offset:320
    ds_read_b128 v[152:155], v194 offset:24576
    ds_read_b128 v[156:159], v184 offset:384
    ds_read_b128 v[160:163], v195 offset:24576
    ds_read_b128 v[164:167], v184 offset:448
    ds_read_b128 v[168:171], v194 offset:32768
    ds_read_b128 v[172:175], v184 offset:512
    ds_read_b128 v[176:179], v195 offset:32768
    ds_read_b128 v[180:183], v184 offset:576
    buffer_load_dwordx4 v[84:87], v2, s[52:55], s17 offen offset:2048 sc1
    s_waitcnt lgkmcnt(15)
    v_mfma_f32_16x16x32_bf16 v[244:247], v[200:203], v[196:199], 0
    v_mfma_f32_16x16x32_bf16 v[244:247], v[208:211], v[204:207], v[244:247]
    s_waitcnt lgkmcnt(14)
    v_mfma_f32_16x16x32_bf16 v[244:247], v[216:219], v[212:215], v[244:247]
    s_waitcnt lgkmcnt(12)
    v_mfma_f32_16x16x32_bf16 v[244:247], v[224:227], v[220:223], v[244:247]
    s_waitcnt lgkmcnt(10)
    v_mfma_f32_16x16x32_bf16 v[244:247], v[232:235], v[228:231], v[244:247]
    ds_read_b128 v[196:199], v194 offset:40960
    ds_read_b128 v[200:203], v184 offset:640
    ds_read_b128 v[204:207], v195 offset:40960
    ds_read_b128 v[208:211], v184 offset:704
    ds_read_b128 v[212:215], v194 offset:49152
    ds_read_b128 v[216:219], v184 offset:768
    ds_read_b128 v[220:223], v195 offset:49152
    ds_read_b128 v[224:227], v184 offset:832
    ds_read_b128 v[228:231], v194 offset:57344
    ds_read_b128 v[232:235], v184 offset:896
    buffer_load_dwordx4 v[88:91], v2, s[52:55], s17 offen offset:3072 sc1
    s_waitcnt lgkmcnt(15)
    v_mfma_f32_16x16x32_bf16 v[244:247], v[148:151], v[144:147], v[244:247]
    v_mfma_f32_16x16x32_bf16 v[244:247], v[156:159], v[152:155], v[244:247]
    s_waitcnt lgkmcnt(14)
    v_mfma_f32_16x16x32_bf16 v[244:247], v[164:167], v[160:163], v[244:247]
    s_waitcnt lgkmcnt(12)
    v_mfma_f32_16x16x32_bf16 v[244:247], v[172:175], v[168:171], v[244:247]
    s_waitcnt lgkmcnt(10)
    v_mfma_f32_16x16x32_bf16 v[244:247], v[180:183], v[176:179], v[244:247]
    ds_read_b128 v[144:147], v195 offset:57344
    ds_read_b128 v[148:151], v184 offset:960
    v_add_u32 v194, 0x10000, v194
    v_add_u32 v195, 0x10000, v195
    ds_read_b128 v[152:155], v194 offset:0
    ds_read_b128 v[156:159], v184 offset:1024
    ds_read_b128 v[160:163], v195 offset:0
    ds_read_b128 v[164:167], v184 offset:1088
    ds_read_b128 v[168:171], v194 offset:8192
    ds_read_b128 v[172:175], v184 offset:1152
    ds_read_b128 v[176:179], v195 offset:8192
    ds_read_b128 v[180:183], v184 offset:1216
    buffer_load_dwordx4 v[92:95], v15, s[52:55], s17 offen sc1
    s_add_u32 s17, s17, 5120
    s_waitcnt lgkmcnt(15)
    v_mfma_f32_16x16x32_bf16 v[244:247], v[200:203], v[196:199], v[244:247]
    v_mfma_f32_16x16x32_bf16 v[244:247], v[208:211], v[204:207], v[244:247]
    s_waitcnt lgkmcnt(14)
    v_mfma_f32_16x16x32_bf16 v[244:247], v[216:219], v[212:215], v[244:247]
    s_waitcnt lgkmcnt(12)
    v_mfma_f32_16x16x32_bf16 v[244:247], v[224:227], v[220:223], v[244:247]
    s_waitcnt lgkmcnt(10)
    v_mfma_f32_16x16x32_bf16 v[244:247], v[232:235], v[228:231], v[244:247]
    buffer_load_dwordx4 v[96:99], v2, s[52:55], s17 offen offset:0 sc1
    s_waitcnt lgkmcnt(8)
    v_mfma_f32_16x16x32_bf16 v[244:247], v[148:151], v[144:147], v[244:247]
    s_waitcnt lgkmcnt(6)
    v_mfma_f32_16x16x32_bf16 v[244:247], v[156:159], v[152:155], v[244:247]
    s_waitcnt lgkmcnt(4)
    v_mfma_f32_16x16x32_bf16 v[244:247], v[164:167], v[160:163], v[244:247]
    s_waitcnt lgkmcnt(2)
    v_mfma_f32_16x16x32_bf16 v[244:247], v[172:175], v[168:171], v[244:247]
    s_waitcnt lgkmcnt(0)
    v_mfma_f32_16x16x32_bf16 v[244:247], v[180:183], v[176:179], v[244:247]
    s_mov_b64 exec, 1
    ds_add_u32 v10, v0 offset:24
    s_mov_b64 exec, -1
    s_setprio 0
    s_mul_i32 s43, s99, 1664525
    s_add_u32 s43, s43, 1013904223
    s_mov_b32 s96, s43
    s_mov_b32 s97, s43
    s_lshl_b32 s73, s41, 12
    s_add_u32 s73, s73, 15206400
    s_lshl_b32 s45, s42, 7
    s_add_u32 s45, s45, s73
    v_lshlrev_b32 v14, 17, v1
    s_waitcnt vmcnt(6)
    s_mov_b64 exec, 1
    ds_add_rtn_u32 v11, v10, v0 offset:4
    s_mov_b64 exec, -1
    s_waitcnt lgkmcnt(0)
    v_readfirstlane_b32 s44, v11
    s_nop 0
    s_cmp_lg_u32 s44, 3
    s_cbranch_scc1 L_nosig
    v_mov_b32 v11, s43
    s_mov_b64 exec, 0xff
    buffer_store_dword v11, v14, s[52:55], s45 offen offset:0 sc1
    s_mov_b64 exec, -1
L_nosig:
    buffer_load_dwordx4 v[100:103], v2, s[52:55], s17 offen offset:1024 sc1
    v_mul_u32_u24 v254, 40, v13
    v_and_b32 v12, 15, v1
    v_mul_u32_u24 v12, 160, v12
    buffer_load_dwordx4 v[104:107], v2, s[52:55], s17 offen offset:2048 sc1
    v_add3_u32 v9, v12, v254, s70
    v_add_u32 v254, 161408, v254
    ds_read_b64 v[144:145], v254 offset:0
    buffer_load_dwordx4 v[108:111], v2, s[52:55], s17 offen offset:3072 sc1
    ds_read_b64 v[146:147], v254 offset:8
    ds_read_b64 v[148:149], v254 offset:16
    ds_read_b64 v[150:151], v254 offset:24
    buffer_load_dwordx4 v[112:115], v15, s[52:55], s17 offen sc1
    s_add_u32 s17, s17, 5120
    ds_read_b64 v[152:153], v254 offset:32
    v_add_u32 v3, s70, v2
    v_add_u32 v4, s50, v2
    s_add_u32 m0, s70, 0
    s_nop 0
    buffer_load_dwordx4 v2, s[52:55], s18 offen offset:0 sc1 lds
    s_xor_b32 s46, s40, 1
    s_mul_i32 s46, s46, 20480
    s_add_u32 s46, s46, 28672
    v_lshl_add_u32 v248, v1, 3, s46
    s_xor_b32 s46, s40, 2
    s_mul_i32 s46, s46, 20480
    s_add_u32 s46, s46, 31232
    v_lshl_add_u32 v249, v1, 3, s46
    s_xor_b32 s46, s40, 3
    s_mul_i32 s46, s46, 20480
    s_add_u32 s46, s46, 33792
    v_lshl_add_u32 v250, v1, 3, s46
    buffer_load_dwordx4 v2, s[52:55], s18 offen offset:1024 sc1 lds
    v_cvt_pk_bf16_f32 v244, v244, v244
    v_and_b32 v244, 0xffff0000, v244
    v_mul_f32 v244, 0xbfb8aa3b, v244
    buffer_load_dwordx4 v2, s[52:55], s18 offen offset:2048 sc1 lds
    v_exp_f32 v244, v244
    v_bfe_u32 v12, v1, 2, 2
    v_add_f32 v244, 1.0, v244
    buffer_load_dwordx4 v2, s[52:55], s18 offen offset:3072 sc1 lds
    s_add_u32 s18, s18, 4096
    v_rcp_f32 v244, v244
    v_mad_u32_u24 v12, v13, 20, v12
    v_cvt_pk_bf16_f32 v244, v244, v244
    s_add_u32 m0, s70, 4096
    s_nop 0
    buffer_load_dwordx4 v2, s[52:55], s18 offen offset:0 sc1 lds
    v_and_b32 v244, 0xffff0000, v244
    v_mov_b32 v245, v244
    v_sub_f32 v246, 1.0, v244
    buffer_load_dwordx4 v2, s[52:55], s18 offen offset:1024 sc1 lds
    v_cvt_pk_bf16_f32 v246, v246, v246
    v_and_b32 v246, 0xffff0000, v246
    v_mov_b32 v247, v246
    buffer_load_dwordx4 v2, s[52:55], s18 offen offset:2048 sc1 lds
    v_lshlrev_b32 v8, 7, v12
    v_and_b32 v12, 1, v1
    v_lshl_add_u32 v8, v12, 6, v8
    buffer_load_dwordx4 v2, s[52:55], s18 offen offset:3072 sc1 lds
    s_add_u32 s18, s18, 4096
    v_and_b32 v12, 2, v1
    v_lshl_add_u32 v8, v12, 2, v8
    s_lshl_b32 s46, s40, 4
    v_add_u32 v8, s46, v8
    s_add_u32 m0, s70, 8192
    s_nop 0
    buffer_load_dwordx4 v2, s[52:55], s18 offen offset:0 sc1 lds
    v_lshrrev_b32 v12, 4, v8
    v_and_b32 v12, 48, v12
    v_xor_b32 v8, v12, v8
    buffer_load_dwordx4 v2, s[52:55], s18 offen offset:1024 sc1 lds
    v_add_u32 v8, 13824, v8
    s_waitcnt lgkmcnt(4)
    v_lshlrev_b32 v116, 16, v144
    v_and_b32 v117, 0xffff0000, v144
    buffer_load_dwordx4 v2, s[52:55], s18 offen offset:2048 sc1 lds
    v_lshlrev_b32 v118, 16, v145
    v_and_b32 v119, 0xffff0000, v145
    s_waitcnt lgkmcnt(3)
    v_lshlrev_b32 v120, 16, v146
    buffer_load_dwordx4 v2, s[52:55], s18 offen offset:3072 sc1 lds
    s_add_u32 s18, s18, 4096
    v_and_b32 v121, 0xffff0000, v146
    v_lshlrev_b32 v122, 16, v147
    v_and_b32 v123, 0xffff0000, v147
    s_waitcnt lgkmcnt(0)
    s_mov_b32 s48, 0
L_spin_8:
    ds_read_b32 v11, v10 offset:24
    s_add_u32 s48, s48, 1
    s_waitcnt lgkmcnt(0)
    v_readfirstlane_b32 s44, v11
    s_nop 0
    s_cmp_ge_u32 s44, 4
    s_cbranch_scc1 L_spun_9
    s_cmp_lt_u32 s48, 400000
    s_cbranch_scc1 L_spin_8
L_spun_9:
    s_add_u32 m0, s50, 0
    s_nop 0
    buffer_load_dwordx4 v2, s[52:55], s18 offen offset:0 sc1 lds
    v_lshlrev_b32 v124, 16, v148
    v_and_b32 v125, 0xffff0000, v148
    v_lshlrev_b32 v126, 16, v149
    buffer_load_dwordx4 v2, s[52:55], s18 offen offset:1024 sc1 lds
    v_and_b32 v127, 0xffff0000, v149
    v_lshlrev_b32 v128, 16, v150
    v_and_b32 v129, 0xffff0000, v150
    buffer_load_dwordx4 v2, s[52:55], s18 offen offset:2048 sc1 lds
    v_lshlrev_b32 v130, 16, v151
    v_and_b32 v131, 0xffff0000, v151
    v_lshlrev_b32 v132, 16, v152
    s_add_u32 m0, s50, 3072
    s_nop 0
    buffer_load_dwordx4 v2, s[52:55], s19 offen offset:0 sc1 lds
    v_and_b32 v133, 0xffff0000, v152
    v_lshlrev_b32 v134, 16, v153
    v_and_b32 v135, 0xffff0000, v153
    buffer_load_dwordx4 v2, s[52:55], s19 offen offset:1024 sc1 lds
    s_and_b32 s51, s42, 1
    s_lshl_b32 s51, s51, 1
    v_add_u32 v12, 0, v1
    v_mul_u32_u24 v5, 5462, v12
    buffer_load_dwordx4 v2, s[52:55], s19 offen offset:2048 sc1 lds
    v_lshrrev_b32 v5, 16, v5
    v_mul_u32_u24 v251, 12, v5
    v_sub_u32 v12, v12, v251
    buffer_load_dwordx4 v2, s[52:55], s19 offen offset:3072 sc1 lds
    s_add_u32 s19, s19, 4096
    v_subrev_u32 v12, s51, v12
    v_cmp_gt_u32 vcc, 10, v12
    v_mul_u32_u24 v251, 160, v5
    v_mul_u32_u24 v5, 1280, v5
    v_cndmask_b32 v12, 0, v12, vcc
    v_lshl_add_u32 v5, v12, 4, v5
    v_cndmask_b32 v5, 1.0, v5, vcc
    v_lshl_add_u32 v251, v12, 4, v251
    s_add_u32 m0, s50, 7168
    s_nop 0
    buffer_load_dwordx4 v2, s[52:55], s19 offen offset:0 sc1 lds
    v_add_u32 v251, s70, v251
    v_add_u32 v12, 64, v1
    v_mul_u32_u24 v6, 5462, v12
    buffer_load_dwordx4 v2, s[52:55], s19 offen offset:1024 sc1 lds
    v_lshrrev_b32 v6, 16, v6
    v_mul_u32_u24 v252, 12, v6
    v_sub_u32 v12, v12, v252
    buffer_load_dwordx4 v2, s[52:55], s19 offen offset:2048 sc1 lds
    v_subrev_u32 v12, s51, v12
    v_cmp_gt_u32 vcc, 10, v12
    v_mul_u32_u24 v252, 160, v6
    v_mul_u32_u24 v6, 1280, v6
    v_cndmask_b32 v12, 0, v12, vcc
    v_lshl_add_u32 v6, v12, 4, v6
    v_cndmask_b32 v6, 1.0, v6, vcc
    v_lshl_add_u32 v252, v12, 4, v252
    s_mov_b32 s64, s34
    s_mov_b32 s65, s35
    s_mov_b32 s66, 0x280000
    s_mov_b32 s67, 0x20000
    s_mul_i32 s45, s42, 160
    s_add_u32 s68, s68, s45
    s_lshl_b32 s46, s40, 8
    s_add_u32 s73, s73, s46
    s_lshl_b32 s46, s42, 17
    s_add_u32 s73, s73, s46
    s_add_u32 s6, s38, s73
    s_addc_u32 s7, s39, 0
    s_load_dword s8, s[6:7], 0 glc
    s_load_dword s9, s[6:7], 128 glc
    buffer_load_dwordx4 v2, s[52:55], s19 offen offset:3072 sc1 lds
    s_add_u32 s19, s19, 4096
    v_add_u32 v252, s70, v252
    v_add_u32 v12, 128, v1
    v_mul_u32_u24 v7, 5462, v12
    s_add_u32 m0, s50, 11264
    s_nop 0
    buffer_load_dwordx4 v2, s[52:55], s19 offen offset:0 sc1 lds
    v_lshrrev_b32 v7, 16, v7
    v_mul_u32_u24 v253, 12, v7
    v_sub_u32 v12, v12, v253
    buffer_load_dwordx4 v2, s[52:55], s19 offen offset:1024 sc1 lds
    v_subrev_u32 v12, s51, v12
    v_cmp_gt_u32 vcc, 10, v12
    v_mul_u32_u24 v253, 160, v7
    v_mul_u32_u24 v7, 1280, v7
    v_cndmask_b32 v12, 0, v12, vcc
    v_lshl_add_u32 v7, v12, 4, v7
    v_cndmask_b32 v7, 1.0, v7, vcc
    v_lshl_add_u32 v253, v12, 4, v253
    buffer_load_dwordx4 v2, s[52:55], s19 offen offset:2048 sc1 lds
    v_add_u32 v253, s70, v253
    buffer_load_dwordx4 v2, s[52:55], s19 offen offset:3072 sc1 lds
    s_add_u32 s19, s19, 4096
    s_add_u32 m0, s50, 15360
    s_nop 0
    buffer_load_dwordx4 v2, s[52:55], s19 offen offset:0 sc1 lds
    buffer_load_dwordx4 v2, s[52:55], s19 offen offset:1024 sc1 lds
    buffer_load_dwordx4 v2, s[52:55], s19 offen offset:2048 sc1 lds
    s_waitcnt lgkmcnt(0)
    s_cmp_eq_u64 s[8:9], s[96:97]
    s_cbranch_scc1 L_h_ready
    s_mov_b32 s48, 0
    s_waitcnt lgkmcnt(0)
L_poll_10:
    s_load_dword s8, s[6:7], 0 glc
    s_load_dword s9, s[6:7], 128 glc
    s_add_u32 s48, s48, 1
    s_cmp_ge_u32 s48, 40000
    s_waitcnt lgkmcnt(0)
    s_cbranch_scc1 L_polled_11
    s_cmp_lg_u64 s[8:9], s[96:97]
    s_cbranch_scc1 L_poll_10
L_polled_11:
L_h_ready:
    buffer_load_dwordx4 v[208:211], v2, s[52:55], s20 offen offset:3072 sc1
    buffer_load_dwordx4 v[204:207], v2, s[52:55], s20 offen offset:2048 sc1
    buffer_load_dwordx4 v[200:203], v2, s[52:55], s20 offen offset:1024 sc1
    buffer_load_dwordx4 v[196:199], v2, s[52:55], s20 offen offset:0 sc1
    s_add_u32 s20, s20, 4096
    buffer_load_dwordx4 v[224:227], v2, s[52:55], s20 offen offset:3072 sc1
    buffer_load_dwordx4 v[220:223], v2, s[52:55], s20 offen offset:2048 sc1
    buffer_load_dwordx4 v[216:219], v2, s[52:55], s20 offen offset:1024 sc1
    buffer_load_dwordx4 v[212:215], v2, s[52:55], s20 offen offset:0 sc1
    s_add_u32 s20, s20, 4096
    buffer_load_dwordx4 v[240:243], v2, s[52:55], s20 offen offset:3072 sc1
    buffer_load_dwordx4 v[236:239], v2, s[52:55], s20 offen offset:2048 sc1
    buffer_load_dwordx4 v[232:235], v2, s[52:55], s20 offen offset:1024 sc1
    buffer_load_dwordx4 v[228:231], v2, s[52:55], s20 offen offset:0 sc1
    s_add_u32 s20, s20, 4096
    s_waitcnt vmcnt(11)
    v_mfma_f32_16x16x32_bf16 v[176:179], v[16:19], v[208:211], 0
    v_mfma_f32_16x16x32_bf16 v[180:183], v[20:23], v[208:211], 0
    v_mfma_f32_16x16x32_bf16 v[184:187], v[24:27], v[208:211], 0
    v_mfma_f32_16x16x32_bf16 v[188:191], v[28:31], v[208:211], 0
    v_mfma_f32_16x16x32_bf16 v[192:195], v[32:35], v[208:211], 0
    s_waitcnt vmcnt(10)
    v_mfma_f32_16x16x32_bf16 v[156:159], v[16:19], v[204:207], 0
    buffer_load_dwordx4 v[208:211], v2, s[52:55], s21 offen offset:3072 sc1
    v_mfma_f32_16x16x32_bf16 v[160:163], v[20:23], v[204:207], 0
    v_mfma_f32_16x16x32_bf16 v[164:167], v[24:27], v[204:207], 0
    v_mfma_f32_16x16x32_bf16 v[168:171], v[28:31], v[204:207], 0
    v_mfma_f32_16x16x32_bf16 v[172:175], v[32:35], v[204:207], 0
    s_waitcnt vmcnt(10)
    v_mfma_f32_16x16x32_bf16 v[136:139], v[16:19], v[200:203], 0
    buffer_load_dwordx4 v[204:207], v2, s[52:55], s21 offen offset:2048 sc1
    v_mfma_f32_16x16x32_bf16 v[140:143], v[20:23], v[200:203], 0
    v_mfma_f32_16x16x32_bf16 v[144:147], v[24:27], v[200:203], 0
    v_mfma_f32_16x16x32_bf16 v[148:151], v[28:31], v[200:203], 0
    v_mfma_f32_16x16x32_bf16 v[152:155], v[32:35], v[200:203], 0
    s_waitcnt vmcnt(10)
    v_mfma_f32_16x16x32_bf16 v[116:119], v[16:19], v[196:199], v[116:119]
    buffer_load_dwordx4 v[200:203], v2, s[52:55], s21 offen offset:1024 sc1
    v_mfma_f32_16x16x32_bf16 v[120:123], v[20:23], v[196:199], v[120:123]
    v_mfma_f32_16x16x32_bf16 v[124:127], v[24:27], v[196:199], v[124:127]
    v_mfma_f32_16x16x32_bf16 v[128:131], v[28:31], v[196:199], v[128:131]
    v_mfma_f32_16x16x32_bf16 v[132:135], v[32:35], v[196:199], v[132:135]
    s_waitcnt vmcnt(9)
    v_mfma_f32_16x16x32_bf16 v[176:179], v[36:39], v[222:225], v[176:179]
    buffer_load_dwordx4 v[196:199], v2, s[52:55], s21 offen offset:0 sc1
    v_mfma_f32_16x16x32_bf16 v[180:183], v[40:43], v[222:225], v[180:183]
    s_add_u32 s21, s21, 4096
    v_mfma_f32_16x16x32_bf16 v[184:187], v[44:47], v[222:225], v[184:187]
    buffer_load_dwordx4 v[16:19], v2, s[52:55], s17 offen offset:0 sc1
    v_mfma_f32_16x16x32_bf16 v[188:191], v[48:51], v[222:225], v[188:191]
    v_mfma_f32_16x16x32_bf16 v[192:195], v[52:55], v[222:225], v[192:195]
    v_mov_b32 v222, v226
    v_mov_b32 v223, v227
    s_waitcnt vmcnt(9)
    v_mfma_f32_16x16x32_bf16 v[136:139], v[36:39], v[214:217], v[136:139]
    buffer_load_dwordx4 v[20:23], v2, s[52:55], s17 offen offset:1024 sc1
    v_mfma_f32_16x16x32_bf16 v[140:143], v[40:43], v[214:217], v[140:143]
    v_mfma_f32_16x16x32_bf16 v[144:147], v[44:47], v[214:217], v[144:147]
    v_mfma_f32_16x16x32_bf16 v[148:151], v[48:51], v[214:217], v[148:151]
    buffer_load_dwordx4 v[24:27], v2, s[52:55], s17 offen offset:2048 sc1
    v_mfma_f32_16x16x32_bf16 v[152:155], v[52:55], v[214:217], v[152:155]
    v_mov_b32 v214, v218
    v_mov_b32 v215, v219
    v_mfma_f32_16x16x32_bf16 v[156:159], v[36:39], v[220:223], v[156:159]
    v_mfma_f32_16x16x32_bf16 v[160:163], v[40:43], v[220:223], v[160:163]
    buffer_load_dwordx4 v[28:31], v2, s[52:55], s17 offen offset:3072 sc1
    v_mfma_f32_16x16x32_bf16 v[164:167], v[44:47], v[220:223], v[164:167]
    v_mfma_f32_16x16x32_bf16 v[168:171], v[48:51], v[220:223], v[168:171]
    v_mfma_f32_16x16x32_bf16 v[172:175], v[52:55], v[220:223], v[172:175]
    buffer_load_dwordx4 v[32:35], v15, s[52:55], s17 offen sc1
    s_add_u32 s17, s17, 5120
    v_mfma_f32_16x16x32_bf16 v[116:119], v[36:39], v[212:215], v[116:119]
    buffer_load_dwordx4 v[224:227], v2, s[52:55], s21 offen offset:3072 sc1
    v_mfma_f32_16x16x32_bf16 v[120:123], v[40:43], v[212:215], v[120:123]
    v_mfma_f32_16x16x32_bf16 v[124:127], v[44:47], v[212:215], v[124:127]
    buffer_load_dwordx4 v[220:223], v2, s[52:55], s21 offen offset:2048 sc1
    v_mfma_f32_16x16x32_bf16 v[128:131], v[48:51], v[212:215], v[128:131]
    v_mfma_f32_16x16x32_bf16 v[132:135], v[52:55], v[212:215], v[132:135]
    s_waitcnt vmcnt(14)
    v_mfma_f32_16x16x32_bf16 v[176:179], v[56:59], v[240:243], v[176:179]
    buffer_load_dwordx4 v[216:219], v2, s[52:55], s21 offen offset:1024 sc1
    v_mfma_f32_16x16x32_bf16 v[180:183], v[60:63], v[240:243], v[180:183]
    v_mfma_f32_16x16x32_bf16 v[184:187], v[64:67], v[240:243], v[184:187]
    buffer_load_dwordx4 v[212:215], v2, s[52:55], s21 offen offset:0 sc1
    v_mfma_f32_16x16x32_bf16 v[188:191], v[68:71], v[240:243], v[188:191]
    s_add_u32 s21, s21, 4096
    v_mfma_f32_16x16x32_bf16 v[192:195], v[72:75], v[240:243], v[192:195]
    s_waitcnt vmcnt(15)
    v_mfma_f32_16x16x32_bf16 v[156:159], v[56:59], v[236:239], v[156:159]
    buffer_load_dwordx4 v[240:243], v2, s[52:55], s21 offen offset:3072 sc1
    v_mfma_f32_16x16x32_bf16 v[160:163], v[60:63], v[236:239], v[160:163]
    v_mfma_f32_16x16x32_bf16 v[164:167], v[64:67], v[236:239], v[164:167]
    v_mfma_f32_16x16x32_bf16 v[168:171], v[68:71], v[236:239], v[168:171]
    v_mfma_f32_16x16x32_bf16 v[172:175], v[72:75], v[236:239], v[172:175]
    s_waitcnt vmcnt(15)
    v_mfma_f32_16x16x32_bf16 v[136:139], v[56:59], v[232:235], v[136:139]
    buffer_load_dwordx4 v[236:239], v2, s[52:55], s21 offen offset:2048 sc1
    v_mfma_f32_16x16x32_bf16 v[140:143], v[60:63], v[232:235], v[140:143]
    v_mfma_f32_16x16x32_bf16 v[144:147], v[64:67], v[232:235], v[144:147]
    v_mfma_f32_16x16x32_bf16 v[148:151], v[68:71], v[232:235], v[148:151]
    v_mfma_f32_16x16x32_bf16 v[152:155], v[72:75], v[232:235], v[152:155]
    s_waitcnt vmcnt(15)
    v_mfma_f32_16x16x32_bf16 v[116:119], v[56:59], v[228:231], v[116:119]
    buffer_load_dwordx4 v[232:235], v2, s[52:55], s21 offen offset:1024 sc1
    v_mfma_f32_16x16x32_bf16 v[120:123], v[60:63], v[228:231], v[120:123]
    v_mfma_f32_16x16x32_bf16 v[124:127], v[64:67], v[228:231], v[124:127]
    v_mfma_f32_16x16x32_bf16 v[128:131], v[68:71], v[228:231], v[128:131]
    v_mfma_f32_16x16x32_bf16 v[132:135], v[72:75], v[228:231], v[132:135]
    s_waitcnt vmcnt(15)
    v_mfma_f32_16x16x32_bf16 v[176:179], v[76:79], v[208:211], v[176:179]
    buffer_load_dwordx4 v[228:231], v2, s[52:55], s21 offen offset:0 sc1
    v_mfma_f32_16x16x32_bf16 v[180:183], v[80:83], v[208:211], v[180:183]
    s_add_u32 s21, s21, 4096
    ds_read_b128 v[36:39], v3 offset:0
    v_mfma_f32_16x16x32_bf16 v[184:187], v[84:87], v[208:211], v[184:187]
    ds_read_b128 v[40:43], v3 offset:1024
    v_mfma_f32_16x16x32_bf16 v[188:191], v[88:91], v[208:211], v[188:191]
    ds_read_b128 v[44:47], v3 offset:2048
    v_mfma_f32_16x16x32_bf16 v[192:195], v[92:95], v[208:211], v[192:195]
    ds_read_b128 v[48:51], v3 offset:3072
    s_waitcnt vmcnt(15)
    v_mfma_f32_16x16x32_bf16 v[156:159], v[76:79], v[204:207], v[156:159]
    buffer_load_dwordx4 v[208:211], v2, s[52:55], s22 offen offset:3072 sc1
    v_mfma_f32_16x16x32_bf16 v[160:163], v[80:83], v[204:207], v[160:163]
    ds_read_b128 v[52:55], v3 offset:4096
    v_mfma_f32_16x16x32_bf16 v[164:167], v[84:87], v[204:207], v[164:167]
    v_mfma_f32_16x16x32_bf16 v[168:171], v[88:91], v[204:207], v[168:171]
    v_mfma_f32_16x16x32_bf16 v[172:175], v[92:95], v[204:207], v[172:175]
    s_waitcnt vmcnt(15)
    v_mfma_f32_16x16x32_bf16 v[136:139], v[76:79], v[200:203], v[136:139]
    buffer_load_dwordx4 v[204:207], v2, s[52:55], s22 offen offset:2048 sc1
    v_mfma_f32_16x16x32_bf16 v[140:143], v[80:83], v[200:203], v[140:143]
    v_mfma_f32_16x16x32_bf16 v[144:147], v[84:87], v[200:203], v[144:147]
    v_mfma_f32_16x16x32_bf16 v[148:151], v[88:91], v[200:203], v[148:151]
    v_mfma_f32_16x16x32_bf16 v[152:155], v[92:95], v[200:203], v[152:155]
    s_waitcnt vmcnt(15)
    v_mfma_f32_16x16x32_bf16 v[116:119], v[76:79], v[196:199], v[116:119]
    buffer_load_dwordx4 v[200:203], v2, s[52:55], s22 offen offset:1024 sc1
    v_mfma_f32_16x16x32_bf16 v[120:123], v[80:83], v[196:199], v[120:123]
    v_mfma_f32_16x16x32_bf16 v[124:127], v[84:87], v[196:199], v[124:127]
    v_mfma_f32_16x16x32_bf16 v[128:131], v[88:91], v[196:199], v[128:131]
    v_mfma_f32_16x16x32_bf16 v[132:135], v[92:95], v[196:199], v[132:135]
    s_waitcnt vmcnt(9)
    v_mfma_f32_16x16x32_bf16 v[176:179], v[96:99], v[222:225], v[176:179]
    buffer_load_dwordx4 v[196:199], v2, s[52:55], s22 offen offset:0 sc1
    v_mfma_f32_16x16x32_bf16 v[180:183], v[100:103], v[222:225], v[180:183]
    s_add_u32 s22, s22, 4096
    ds_read_b128 v[56:59], v3 offset:5120
    v_mfma_f32_16x16x32_bf16 v[184:187], v[104:107], v[222:225], v[184:187]
    ds_read_b128 v[60:63], v3 offset:6144
    v_mfma_f32_16x16x32_bf16 v[188:191], v[108:111], v[222:225], v[188:191]
    ds_read_b128 v[64:67], v3 offset:7168
    v_mfma_f32_16x16x32_bf16 v[192:195], v[112:115], v[222:225], v[192:195]
    ds_read_b128 v[68:71], v3 offset:8192
    v_mov_b32 v222, v226
    v_mov_b32 v223, v227
    s_waitcnt vmcnt(8)
    v_mfma_f32_16x16x32_bf16 v[136:139], v[96:99], v[214:217], v[136:139]
    ds_read_b128 v[72:75], v3 offset:9216
    v_mfma_f32_16x16x32_bf16 v[140:143], v[100:103], v[214:217], v[140:143]
    v_mfma_f32_16x16x32_bf16 v[144:147], v[104:107], v[214:217], v[144:147]
    v_mfma_f32_16x16x32_bf16 v[148:151], v[108:111], v[214:217], v[148:151]
    v_mfma_f32_16x16x32_bf16 v[152:155], v[112:115], v[214:217], v[152:155]
    v_mov_b32 v214, v218
    v_mov_b32 v215, v219
    v_mfma_f32_16x16x32_bf16 v[156:159], v[96:99], v[220:223], v[156:159]
    v_mfma_f32_16x16x32_bf16 v[160:163], v[100:103], v[220:223], v[160:163]
    v_mfma_f32_16x16x32_bf16 v[164:167], v[104:107], v[220:223], v[164:167]
    v_mfma_f32_16x16x32_bf16 v[168:171], v[108:111], v[220:223], v[168:171]
    v_mfma_f32_16x16x32_bf16 v[172:175], v[112:115], v[220:223], v[172:175]
    v_mfma_f32_16x16x32_bf16 v[116:119], v[96:99], v[212:215], v[116:119]
    buffer_load_dwordx4 v[224:227], v2, s[52:55], s22 offen offset:3072 sc1
    v_mfma_f32_16x16x32_bf16 v[120:123], v[100:103], v[212:215], v[120:123]
    v_mfma_f32_16x16x32_bf16 v[124:127], v[104:107], v[212:215], v[124:127]
    buffer_load_dwordx4 v[220:223], v2, s[52:55], s22 offen offset:2048 sc1
    v_mfma_f32_16x16x32_bf16 v[128:131], v[108:111], v[212:215], v[128:131]
    v_mfma_f32_16x16x32_bf16 v[132:135], v[112:115], v[212:215], v[132:135]
    s_waitcnt vmcnt(9)
    v_mfma_f32_16x16x32_bf16 v[176:179], v[16:19], v[240:243], v[176:179]
    buffer_load_dwordx4 v[216:219], v2, s[52:55], s22 offen offset:1024 sc1
    v_mfma_f32_16x16x32_bf16 v[180:183], v[20:23], v[240:243], v[180:183]
    ds_read_b128 v[76:79], v3 offset:10240
    v_mfma_f32_16x16x32_bf16 v[184:187], v[24:27], v[240:243], v[184:187]
    buffer_load_dwordx4 v[212:215], v2, s[52:55], s22 offen offset:0 sc1
    v_mfma_f32_16x16x32_bf16 v[188:191], v[28:31], v[240:243], v[188:191]
    s_add_u32 s22, s22, 4096
    ds_read_b128 v[80:83], v3 offset:11264
    v_mfma_f32_16x16x32_bf16 v[192:195], v[32:35], v[240:243], v[192:195]
    ds_read_b128 v[84:87], v4 offset:0
    s_waitcnt vmcnt(10)
    v_mfma_f32_16x16x32_bf16 v[156:159], v[16:19], v[236:239], v[156:159]
    buffer_load_dwordx4 v[240:243], v2, s[52:55], s22 offen offset:3072 sc1
    v_mfma_f32_16x16x32_bf16 v[160:163], v[20:23], v[236:239], v[160:163]
    ds_read_b128 v[88:91], v4 offset:1024
    v_mfma_f32_16x16x32_bf16 v[164:167], v[24:27], v[236:239], v[164:167]
    ds_read_b128 v[92:95], v4 offset:2048
    v_mfma_f32_16x16x32_bf16 v[168:171], v[28:31], v[236:239], v[168:171]
    v_mfma_f32_16x16x32_bf16 v[172:175], v[32:35], v[236:239], v[172:175]
    s_waitcnt vmcnt(10)
    v_mfma_f32_16x16x32_bf16 v[136:139], v[16:19], v[232:235], v[136:139]
    buffer_load_dwordx4 v[236:239], v2, s[52:55], s22 offen offset:2048 sc1
    v_mfma_f32_16x16x32_bf16 v[140:143], v[20:23], v[232:235], v[140:143]
    v_mfma_f32_16x16x32_bf16 v[144:147], v[24:27], v[232:235], v[144:147]
    v_mfma_f32_16x16x32_bf16 v[148:151], v[28:31], v[232:235], v[148:151]
    v_mfma_f32_16x16x32_bf16 v[152:155], v[32:35], v[232:235], v[152:155]
    s_waitcnt vmcnt(10)
    v_mfma_f32_16x16x32_bf16 v[116:119], v[16:19], v[228:231], v[116:119]
    buffer_load_dwordx4 v[232:235], v2, s[52:55], s22 offen offset:1024 sc1
    v_mfma_f32_16x16x32_bf16 v[120:123], v[20:23], v[228:231], v[120:123]
    v_mfma_f32_16x16x32_bf16 v[124:127], v[24:27], v[228:231], v[124:127]
    v_mfma_f32_16x16x32_bf16 v[128:131], v[28:31], v[228:231], v[128:131]
    v_mfma_f32_16x16x32_bf16 v[132:135], v[32:35], v[228:231], v[132:135]
    s_waitcnt lgkmcnt(10)
    s_waitcnt vmcnt(10)
    v_mfma_f32_16x16x32_bf16 v[176:179], v[36:39], v[208:211], v[176:179]
    buffer_load_dwordx4 v[228:231], v2, s[52:55], s22 offen offset:0 sc1
    v_mfma_f32_16x16x32_bf16 v[180:183], v[40:43], v[208:211], v[180:183]
    s_add_u32 s22, s22, 4096
    ds_read_b128 v[96:99], v4 offset:3072
    v_mfma_f32_16x16x32_bf16 v[184:187], v[44:47], v[208:211], v[184:187]
    ds_read_b128 v[100:103], v4 offset:4096
    v_mfma_f32_16x16x32_bf16 v[188:191], v[48:51], v[208:211], v[188:191]
    ds_read_b128 v[104:107], v4 offset:5120
    v_mfma_f32_16x16x32_bf16 v[192:195], v[52:55], v[208:211], v[192:195]
    ds_read_b128 v[108:111], v4 offset:6144
    s_waitcnt vmcnt(10)
    v_mfma_f32_16x16x32_bf16 v[156:159], v[36:39], v[204:207], v[156:159]
    buffer_load_dwordx4 v[208:211], v2, s[52:55], s23 offen offset:3072 sc1
    v_mfma_f32_16x16x32_bf16 v[160:163], v[40:43], v[204:207], v[160:163]
    ds_read_b128 v[112:115], v4 offset:7168
    v_mfma_f32_16x16x32_bf16 v[164:167], v[44:47], v[204:207], v[164:167]
    v_mfma_f32_16x16x32_bf16 v[168:171], v[48:51], v[204:207], v[168:171]
    v_mfma_f32_16x16x32_bf16 v[172:175], v[52:55], v[204:207], v[172:175]
    s_waitcnt vmcnt(10)
    v_mfma_f32_16x16x32_bf16 v[136:139], v[36:39], v[200:203], v[136:139]
    buffer_load_dwordx4 v[204:207], v2, s[52:55], s23 offen offset:2048 sc1
    v_mfma_f32_16x16x32_bf16 v[140:143], v[40:43], v[200:203], v[140:143]
    v_mfma_f32_16x16x32_bf16 v[144:147], v[44:47], v[200:203], v[144:147]
    v_mfma_f32_16x16x32_bf16 v[148:151], v[48:51], v[200:203], v[148:151]
    v_mfma_f32_16x16x32_bf16 v[152:155], v[52:55], v[200:203], v[152:155]
    s_waitcnt vmcnt(10)
    v_mfma_f32_16x16x32_bf16 v[116:119], v[36:39], v[196:199], v[116:119]
    buffer_load_dwordx4 v[200:203], v2, s[52:55], s23 offen offset:1024 sc1
    v_mfma_f32_16x16x32_bf16 v[120:123], v[40:43], v[196:199], v[120:123]
    v_mfma_f32_16x16x32_bf16 v[124:127], v[44:47], v[196:199], v[124:127]
    v_mfma_f32_16x16x32_bf16 v[128:131], v[48:51], v[196:199], v[128:131]
    v_mfma_f32_16x16x32_bf16 v[132:135], v[52:55], v[196:199], v[132:135]
    s_waitcnt lgkmcnt(10)
    s_waitcnt vmcnt(9)
    v_mfma_f32_16x16x32_bf16 v[176:179], v[56:59], v[222:225], v[176:179]
    buffer_load_dwordx4 v[196:199], v2, s[52:55], s23 offen offset:0 sc1
    v_mfma_f32_16x16x32_bf16 v[180:183], v[60:63], v[222:225], v[180:183]
    s_add_u32 s23, s23, 4096
    ds_read_b128 v[16:19], v4 offset:8192
    v_mfma_f32_16x16x32_bf16 v[184:187], v[64:67], v[222:225], v[184:187]
    ds_read_b128 v[20:23], v4 offset:9216
    v_mfma_f32_16x16x32_bf16 v[188:191], v[68:71], v[222:225], v[188:191]
    ds_read_b128 v[24:27], v4 offset:10240
    v_mfma_f32_16x16x32_bf16 v[192:195], v[72:75], v[222:225], v[192:195]
    ds_read_b128 v[28:31], v4 offset:11264
    v_mov_b32 v222, v226
    v_mov_b32 v223, v227
    s_waitcnt vmcnt(8)
    v_mfma_f32_16x16x32_bf16 v[136:139], v[56:59], v[214:217], v[136:139]
    ds_read_b128 v[32:35], v4 offset:12288
    v_mfma_f32_16x16x32_bf16 v[140:143], v[60:63], v[214:217], v[140:143]
    v_mfma_f32_16x16x32_bf16 v[144:147], v[64:67], v[214:217], v[144:147]
    v_mfma_f32_16x16x32_bf16 v[148:151], v[68:71], v[214:217], v[148:151]
    v_mfma_f32_16x16x32_bf16 v[152:155], v[72:75], v[214:217], v[152:155]
    v_mov_b32 v214, v218
    v_mov_b32 v215, v219
    v_mfma_f32_16x16x32_bf16 v[156:159], v[56:59], v[220:223], v[156:159]
    v_mfma_f32_16x16x32_bf16 v[160:163], v[60:63], v[220:223], v[160:163]
    v_mfma_f32_16x16x32_bf16 v[164:167], v[64:67], v[220:223], v[164:167]
    v_mfma_f32_16x16x32_bf16 v[168:171], v[68:71], v[220:223], v[168:171]
    v_mfma_f32_16x16x32_bf16 v[172:175], v[72:75], v[220:223], v[172:175]
    v_mfma_f32_16x16x32_bf16 v[116:119], v[56:59], v[212:215], v[116:119]
    buffer_load_dwordx4 v[224:227], v2, s[52:55], s23 offen offset:3072 sc1
    v_mfma_f32_16x16x32_bf16 v[120:123], v[60:63], v[212:215], v[120:123]
    v_mfma_f32_16x16x32_bf16 v[124:127], v[64:67], v[212:215], v[124:127]
    buffer_load_dwordx4 v[220:223], v2, s[52:55], s23 offen offset:2048 sc1
    v_mfma_f32_16x16x32_bf16 v[128:131], v[68:71], v[212:215], v[128:131]
    v_mfma_f32_16x16x32_bf16 v[132:135], v[72:75], v[212:215], v[132:135]
    s_waitcnt lgkmcnt(10)
    s_waitcnt vmcnt(9)
    v_mfma_f32_16x16x32_bf16 v[176:179], v[76:79], v[240:243], v[176:179]
    buffer_load_dwordx4 v[216:219], v2, s[52:55], s23 offen offset:1024 sc1
    v_mfma_f32_16x16x32_bf16 v[180:183], v[80:83], v[240:243], v[180:183]
    ds_read_b128 v[36:39], v4 offset:13312
    v_mfma_f32_16x16x32_bf16 v[184:187], v[84:87], v[240:243], v[184:187]
    buffer_load_dwordx4 v[212:215], v2, s[52:55], s23 offen offset:0 sc1
    v_mfma_f32_16x16x32_bf16 v[188:191], v[88:91], v[240:243], v[188:191]
    s_add_u32 s23, s23, 4096
    ds_read_b128 v[40:43], v4 offset:14336
    v_mfma_f32_16x16x32_bf16 v[192:195], v[92:95], v[240:243], v[192:195]
    ds_read_b128 v[44:47], v4 offset:15360
    s_waitcnt vmcnt(10)
    v_mfma_f32_16x16x32_bf16 v[156:159], v[76:79], v[236:239], v[156:159]
    buffer_load_dwordx4 v[240:243], v2, s[52:55], s23 offen offset:3072 sc1
    v_mfma_f32_16x16x32_bf16 v[160:163], v[80:83], v[236:239], v[160:163]
    ds_read_b128 v[48:51], v4 offset:16384
    v_mfma_f32_16x16x32_bf16 v[164:167], v[84:87], v[236:239], v[164:167]
    ds_read_b128 v[52:55], v4 offset:17408
    v_mfma_f32_16x16x32_bf16 v[168:171], v[88:91], v[236:239], v[168:171]
    v_mfma_f32_16x16x32_bf16 v[172:175], v[92:95], v[236:239], v[172:175]
    s_waitcnt vmcnt(10)
    v_mfma_f32_16x16x32_bf16 v[136:139], v[76:79], v[232:235], v[136:139]
    buffer_load_dwordx4 v[236:239], v2, s[52:55], s23 offen offset:2048 sc1
    v_mfma_f32_16x16x32_bf16 v[140:143], v[80:83], v[232:235], v[140:143]
    v_mfma_f32_16x16x32_bf16 v[144:147], v[84:87], v[232:235], v[144:147]
    v_mfma_f32_16x16x32_bf16 v[148:151], v[88:91], v[232:235], v[148:151]
    v_mfma_f32_16x16x32_bf16 v[152:155], v[92:95], v[232:235], v[152:155]
    s_waitcnt vmcnt(10)
    v_mfma_f32_16x16x32_bf16 v[116:119], v[76:79], v[228:231], v[116:119]
    buffer_load_dwordx4 v[232:235], v2, s[52:55], s23 offen offset:1024 sc1
    v_mfma_f32_16x16x32_bf16 v[120:123], v[80:83], v[228:231], v[120:123]
    v_mfma_f32_16x16x32_bf16 v[124:127], v[84:87], v[228:231], v[124:127]
    v_mfma_f32_16x16x32_bf16 v[128:131], v[88:91], v[228:231], v[128:131]
    v_mfma_f32_16x16x32_bf16 v[132:135], v[92:95], v[228:231], v[132:135]
    s_waitcnt lgkmcnt(0)
    s_waitcnt vmcnt(10)
    v_mfma_f32_16x16x32_bf16 v[176:179], v[96:99], v[208:211], v[176:179]
    buffer_load_dwordx4 v[228:231], v2, s[52:55], s23 offen offset:0 sc1
    v_mfma_f32_16x16x32_bf16 v[180:183], v[100:103], v[208:211], v[180:183]
    s_add_u32 s23, s23, 4096
    v_lshrrev_b32 v13, 4, v1
    v_mfma_f32_16x16x32_bf16 v[184:187], v[104:107], v[208:211], v[184:187]
    v_bfe_u32 v14, v1, 2, 2
    v_mfma_f32_16x16x32_bf16 v[188:191], v[108:111], v[208:211], v[188:191]
    v_cmp_eq_u32 vcc, v13, v14
    v_mfma_f32_16x16x32_bf16 v[192:195], v[112:115], v[208:211], v[192:195]
    v_and_b32 v13, 1, v1
    v_lshlrev_b32 v13, 4, v13
    s_waitcnt vmcnt(10)
    v_mfma_f32_16x16x32_bf16 v[156:159], v[96:99], v[204:207], v[156:159]
    v_mov_b32 v14, 0x3f80
    v_lshlrev_b32 v14, v13, v14
    v_mfma_f32_16x16x32_bf16 v[160:163], v[100:103], v[204:207], v[160:163]
    v_cndmask_b32 v14, 0, v14, vcc
    v_and_b32 v13, 2, v1
    v_mfma_f32_16x16x32_bf16 v[164:167], v[104:107], v[204:207], v[164:167]
    v_cmp_eq_u32 vcc, 0, v13
    v_mov_b32 v56, 0
    v_mfma_f32_16x16x32_bf16 v[168:171], v[108:111], v[204:207], v[168:171]
    v_mov_b32 v57, 0
    v_mov_b32 v62, 0
    v_mfma_f32_16x16x32_bf16 v[172:175], v[112:115], v[204:207], v[172:175]
    v_cndmask_b32 v58, 0, v14, vcc
    v_mov_b32 v63, 0
    s_waitcnt vmcnt(9)
    v_mfma_f32_16x16x32_bf16 v[136:139], v[96:99], v[200:203], v[136:139]
    v_sub_u32 v59, v14, v58
    v_mov_b32 v60, v58
    v_mfma_f32_16x16x32_bf16 v[140:143], v[100:103], v[200:203], v[140:143]
    v_mov_b32 v61, v59
    v_lshl_add_u32 v12, v1, 3, s50
    v_mfma_f32_16x16x32_bf16 v[144:147], v[104:107], v[200:203], v[144:147]
    v_xor_b32 v3, 32, v8
    v_mfma_f32_16x16x32_bf16 v[148:151], v[108:111], v[200:203], v[148:151]
    v_mfma_f32_16x16x32_bf16 v[152:155], v[112:115], v[200:203], v[152:155]
    s_waitcnt vmcnt(8)
    v_mfma_f32_16x16x32_bf16 v[116:119], v[96:99], v[196:199], v[116:119]
    v_mfma_f32_16x16x32_bf16 v[120:123], v[100:103], v[196:199], v[120:123]
    v_mfma_f32_16x16x32_bf16 v[124:127], v[104:107], v[196:199], v[124:127]
    v_mfma_f32_16x16x32_bf16 v[128:131], v[108:111], v[196:199], v[128:131]
    v_mfma_f32_16x16x32_bf16 v[132:135], v[112:115], v[196:199], v[132:135]
    s_waitcnt vmcnt(6)
    v_mfma_f32_16x16x32_bf16 v[176:179], v[16:19], v[222:225], v[176:179]
    v_mfma_f32_16x16x32_bf16 v[180:183], v[20:23], v[222:225], v[180:183]
    v_mfma_f32_16x16x32_bf16 v[184:187], v[24:27], v[222:225], v[184:187]
    v_mfma_f32_16x16x32_bf16 v[188:191], v[28:31], v[222:225], v[188:191]
    v_mfma_f32_16x16x32_bf16 v[192:195], v[32:35], v[222:225], v[192:195]
    v_mov_b32 v222, v226
    v_mov_b32 v223, v227
    s_waitcnt vmcnt(3)
    v_mfma_f32_16x16x32_bf16 v[176:179], v[36:39], v[240:243], v[176:179]
    v_mfma_f32_16x16x32_bf16 v[180:183], v[40:43], v[240:243], v[180:183]
    v_mfma_f32_16x16x32_bf16 v[184:187], v[44:47], v[240:243], v[184:187]
    v_mfma_f32_16x16x32_bf16 v[188:191], v[48:51], v[240:243], v[188:191]
    v_mfma_f32_16x16x32_bf16 v[192:195], v[52:55], v[240:243], v[192:195]
    v_mfma_f32_16x16x32_bf16 v[156:159], v[16:19], v[220:223], v[156:159]
    v_mfma_f32_16x16x32_bf16 v[160:163], v[20:23], v[220:223], v[160:163]
    v_mfma_f32_16x16x32_bf16 v[164:167], v[24:27], v[220:223], v[164:167]
    v_mfma_f32_16x16x32_bf16 v[168:171], v[28:31], v[220:223], v[168:171]
    v_cvt_pk_bf16_f32 v176, v176, v177
    v_cvt_pk_bf16_f32 v177, v178, v179
    v_mfma_f32_16x16x32_bf16 v[172:175], v[32:35], v[220:223], v[172:175]
    ds_write_b64 v12, v[176:177] offset:5120
    s_waitcnt vmcnt(2)
    v_mfma_f32_16x16x32_bf16 v[156:159], v[36:39], v[236:239], v[156:159]
    v_cvt_pk_bf16_f32 v180, v180, v181
    v_cvt_pk_bf16_f32 v181, v182, v183
    v_mfma_f32_16x16x32_bf16 v[160:163], v[40:43], v[236:239], v[160:163]
    ds_write_b64 v12, v[180:181] offset:5632
    v_mfma_f32_16x16x32_bf16 v[164:167], v[44:47], v[236:239], v[164:167]
    v_cvt_pk_bf16_f32 v184, v184, v185
    v_cvt_pk_bf16_f32 v185, v186, v187
    v_mfma_f32_16x16x32_bf16 v[168:171], v[48:51], v[236:239], v[168:171]
    ds_write_b64 v12, v[184:185] offset:6144
    v_mfma_f32_16x16x32_bf16 v[172:175], v[52:55], v[236:239], v[172:175]
    v_cvt_pk_bf16_f32 v188, v188, v189
    v_cvt_pk_bf16_f32 v189, v190, v191
    v_mfma_f32_16x16x32_bf16 v[136:139], v[16:19], v[214:217], v[136:139]
    ds_write_b64 v12, v[188:189] offset:6656
    v_mfma_f32_16x16x32_bf16 v[140:143], v[20:23], v[214:217], v[140:143]
    v_cvt_pk_bf16_f32 v192, v192, v193
    v_cvt_pk_bf16_f32 v193, v194, v195
    v_mfma_f32_16x16x32_bf16 v[144:147], v[24:27], v[214:217], v[144:147]
    ds_write_b64 v12, v[192:193] offset:7168
    v_mfma_f32_16x16x32_bf16 v[148:151], v[28:31], v[214:217], v[148:151]
    v_cvt_pk_bf16_f32 v156, v156, v157
    v_cvt_pk_bf16_f32 v157, v158, v159
    v_mfma_f32_16x16x32_bf16 v[152:155], v[32:35], v[214:217], v[152:155]
    ds_write_b64 v12, v[156:157] offset:2560
    v_mov_b32 v214, v218
    v_mov_b32 v215, v219
    s_waitcnt vmcnt(1)
    v_mfma_f32_16x16x32_bf16 v[136:139], v[36:39], v[232:235], v[136:139]
    v_cvt_pk_bf16_f32 v160, v160, v161
    v_cvt_pk_bf16_f32 v161, v162, v163
    v_mfma_f32_16x16x32_bf16 v[140:143], v[40:43], v[232:235], v[140:143]
    ds_write_b64 v12, v[160:161] offset:3072
    v_mfma_f32_16x16x32_bf16 v[144:147], v[44:47], v[232:235], v[144:147]
    v_cvt_pk_bf16_f32 v164, v164, v165
    v_cvt_pk_bf16_f32 v165, v166, v167
    v_mfma_f32_16x16x32_bf16 v[148:151], v[48:51], v[232:235], v[148:151]
    ds_write_b64 v12, v[164:165] offset:3584
    v_mfma_f32_16x16x32_bf16 v[152:155], v[52:55], v[232:235], v[152:155]
    v_cvt_pk_bf16_f32 v168, v168, v169
    v_cvt_pk_bf16_f32 v169, v170, v171
    v_mfma_f32_16x16x32_bf16 v[116:119], v[16:19], v[212:215], v[116:119]
    ds_write_b64 v12, v[168:169] offset:4096
    v_mfma_f32_16x16x32_bf16 v[120:123], v[20:23], v[212:215], v[120:123]
    v_cvt_pk_bf16_f32 v172, v172, v173
    v_cvt_pk_bf16_f32 v173, v174, v175
    v_mfma_f32_16x16x32_bf16 v[124:127], v[24:27], v[212:215], v[124:127]
    ds_write_b64 v12, v[172:173] offset:4608
    v_mfma_f32_16x16x32_bf16 v[128:131], v[28:31], v[212:215], v[128:131]
    v_cvt_pk_bf16_f32 v136, v136, v137
    v_cvt_pk_bf16_f32 v137, v138, v139
    v_mfma_f32_16x16x32_bf16 v[132:135], v[32:35], v[212:215], v[132:135]
    ds_write_b64 v12, v[136:137] offset:0
    s_waitcnt vmcnt(0)
    v_mfma_f32_16x16x32_bf16 v[116:119], v[36:39], v[228:231], v[116:119]
    v_cvt_pk_bf16_f32 v140, v140, v141
    v_cvt_pk_bf16_f32 v141, v142, v143
    v_mfma_f32_16x16x32_bf16 v[120:123], v[40:43], v[228:231], v[120:123]
    ds_write_b64 v12, v[140:141] offset:512
    v_mfma_f32_16x16x32_bf16 v[124:127], v[44:47], v[228:231], v[124:127]
    v_cvt_pk_bf16_f32 v144, v144, v145
    v_cvt_pk_bf16_f32 v145, v146, v147
    v_mfma_f32_16x16x32_bf16 v[128:131], v[48:51], v[228:231], v[128:131]
    ds_write_b64 v12, v[144:145] offset:1024
    v_mfma_f32_16x16x32_bf16 v[132:135], v[52:55], v[228:231], v[132:135]
    v_cvt_pk_bf16_f32 v148, v148, v149
    v_cvt_pk_bf16_f32 v149, v150, v151
    ds_write_b64 v12, v[148:149] offset:1536
    v_cvt_pk_bf16_f32 v152, v152, v153
    v_cvt_pk_bf16_f32 v153, v154, v155
    ds_write_b64 v12, v[152:153] offset:2048
    s_waitcnt lgkmcnt(0)
    s_barrier
    ds_read_b64 v[136:137], v248 offset:0
    ds_read_b64 v[138:139], v249 offset:0
    ds_read_b64 v[156:157], v250 offset:0
    ds_read_b64_tr_b16 v[158:159], v8 offset:0
    ds_read_b64 v[140:141], v248 offset:512
    ds_read_b64 v[142:143], v249 offset:512
    ds_read_b64 v[160:161], v250 offset:512
    ds_read_b64_tr_b16 v[162:163], v3 offset:512
    ds_read_b64 v[144:145], v248 offset:1024
    ds_read_b64 v[146:147], v249 offset:1024
    ds_read_b64 v[164:165], v250 offset:1024
    ds_read_b64_tr_b16 v[166:167], v8 offset:1024
    s_waitcnt lgkmcnt(10)
    v_mfma_f32_16x16x32_bf16 v[116:119], v[58:61], v[136:139], v[116:119]
    ds_read_b64 v[148:149], v248 offset:1536
    ds_read_b64 v[150:151], v249 offset:1536
    s_waitcnt lgkmcnt(10)
    v_mfma_f32_16x16x32_bf16 v[208:211], v[56:59], v[156:159], 0
    ds_read_b64 v[168:169], v250 offset:1536
    ds_read_b64_tr_b16 v[170:171], v3 offset:1536
    v_mfma_f32_16x16x32_bf16 v[116:119], v[60:63], v[156:159], v[116:119]
    ds_read_b64 v[152:153], v248 offset:2048
    ds_read_b64 v[154:155], v249 offset:2048
    s_waitcnt lgkmcnt(12)
    v_mfma_f32_16x16x32_bf16 v[120:123], v[58:61], v[140:143], v[120:123]
    ds_read_b64 v[172:173], v250 offset:2048
    ds_read_b64_tr_b16 v[174:175], v8 offset:2048
    s_waitcnt lgkmcnt(12)
    v_mfma_f32_16x16x32_bf16 v[212:215], v[56:59], v[160:163], 0
    v_mfma_f32_16x16x32_bf16 v[120:123], v[60:63], v[160:163], v[120:123]
    s_waitcnt lgkmcnt(10)
    v_mfma_f32_16x16x32_bf16 v[124:127], v[58:61], v[144:147], v[124:127]
    v_mul_f32 v208, v208, v244
    v_mul_f32 v209, v209, v244
    s_waitcnt lgkmcnt(8)
    v_mfma_f32_16x16x32_bf16 v[216:219], v[56:59], v[164:167], 0
    v_mul_f32 v210, v210, v244
    v_mul_f32 v211, v211, v244
    v_mfma_f32_16x16x32_bf16 v[124:127], v[60:63], v[164:167], v[124:127]
    v_fmac_f32 v208, v116, v246
    v_fmac_f32 v209, v117, v246
    s_waitcnt lgkmcnt(6)
    v_mfma_f32_16x16x32_bf16 v[128:131], v[58:61], v[148:151], v[128:131]
    v_fmac_f32 v210, v118, v246
    v_fmac_f32 v211, v119, v246
    s_waitcnt lgkmcnt(4)
    v_mfma_f32_16x16x32_bf16 v[220:223], v[56:59], v[168:171], 0
    v_cvt_pk_bf16_f32 v196, v208, v209
    v_cvt_pk_bf16_f32 v197, v210, v211
    v_mfma_f32_16x16x32_bf16 v[128:131], v[60:63], v[168:171], v[128:131]
    ds_write_b64 v9, v[196:197] offset:0
    v_mul_f32 v212, v212, v244
    s_waitcnt lgkmcnt(3)
    v_mfma_f32_16x16x32_bf16 v[132:135], v[58:61], v[152:155], v[132:135]
    v_mul_f32 v213, v213, v244
    v_mul_f32 v214, v214, v244
    s_waitcnt lgkmcnt(1)
    v_mfma_f32_16x16x32_bf16 v[224:227], v[56:59], v[172:175], 0
    v_mul_f32 v215, v215, v244
    v_fmac_f32 v212, v120, v246
    v_mfma_f32_16x16x32_bf16 v[132:135], v[60:63], v[172:175], v[132:135]
    v_fmac_f32 v213, v121, v246
    v_fmac_f32 v214, v122, v246
    v_fmac_f32 v215, v123, v246
    v_cvt_pk_bf16_f32 v198, v212, v213
    v_cvt_pk_bf16_f32 v199, v214, v215
    ds_write_b64 v9, v[198:199] offset:8
    v_pk_mul_f32 v[216:217], v[216:217], v[244:245]
    v_pk_mul_f32 v[218:219], v[218:219], v[244:245]
    v_pk_fma_f32 v[216:217], v[124:125], v[246:247], v[216:217]
    v_pk_fma_f32 v[218:219], v[126:127], v[246:247], v[218:219]
    v_cvt_pk_bf16_f32 v200, v216, v217
    v_cvt_pk_bf16_f32 v201, v218, v219
    ds_write_b64 v9, v[200:201] offset:16
    v_pk_mul_f32 v[220:221], v[220:221], v[244:245]
    v_pk_mul_f32 v[222:223], v[222:223], v[244:245]
    v_pk_fma_f32 v[220:221], v[128:129], v[246:247], v[220:221]
    v_pk_fma_f32 v[222:223], v[130:131], v[246:247], v[222:223]
    v_cvt_pk_bf16_f32 v202, v220, v221
    v_cvt_pk_bf16_f32 v203, v222, v223
    ds_write_b64 v9, v[202:203] offset:24
    v_pk_mul_f32 v[224:225], v[224:225], v[244:245]
    v_pk_mul_f32 v[226:227], v[226:227], v[244:245]
    v_pk_fma_f32 v[224:225], v[132:133], v[246:247], v[224:225]
    v_pk_fma_f32 v[226:227], v[134:135], v[246:247], v[226:227]
    v_cvt_pk_bf16_f32 v204, v224, v225
    v_cvt_pk_bf16_f32 v205, v226, v227
    ds_write_b64 v9, v[204:205] offset:32
    ds_read_b128 v[208:211], v251
    ds_read_b128 v[212:215], v252
    ds_read_b128 v[216:219], v253
    s_waitcnt lgkmcnt(2)
    buffer_store_dwordx4 v[208:211], v5, s[64:67], s68 offen sc1
    s_waitcnt lgkmcnt(1)
    buffer_store_dwordx4 v[212:215], v6, s[64:67], s68 offen sc1
    s_waitcnt lgkmcnt(0)
    buffer_store_dwordx4 v[216:219], v7, s[64:67], s68 offen sc1
    s_or_b32 s45, s42, s40
    s_cmp_lg_u32 s45, 0
    s_cbranch_scc1 L_end
    s_lshl_b32 s45, s41, 7
    s_add_u32 s45, s45, 1024
    v_mov_b32 v12, s43
    s_mov_b64 exec, 1
    buffer_store_dword v12, off, s[52:55], s45 sc1
    s_mov_b64 exec, -1
    s_endpgm
L_conv_body:
    s_mov_b32 s52, s38
    s_mov_b32 s53, s39
    s_mov_b32 s54, 0x1000000
    s_mov_b32 s55, 0x20000
    s_lshl_b32 s71, s73, 7
    s_mul_i32 s44, s42, 331776
    s_add_u32 s71, s71, s44
    s_add_u32 s71, s71, 3670016
    s_mul_i32 s70, s68, 4608
    v_and_b32 v44, 15, v1
    v_lshrrev_b32 v45, 4, v1
    v_lshlrev_b32 v43, 3, v45
    v_mul_u32_u24 v2, 288, v44
    v_lshl_add_u32 v2, v45, 4, v2
    v_add_u32 v2, s70, v2
    v_lshlrev_b32 v3, 5, v44
    v_lshl_add_u32 v3, v45, 4, v3
    s_add_u32 s44, s70, 13824
    v_add_u32 v3, s44, v3
    v_sub_u32 v41, v43, v44
    v_lshlrev_b32 v252, 2, v41
    v_add_u32 v252, 161660, v252
    v_add_u32 v253, 1024, v252
    v_and_b32 v42, 1, v1
    v_mul_u32_u24 v42, 1218, v42
    v_lshlrev_b32 v4, 1, v41
    v_sub_u32 v4, v4, v42
    s_add_u32 s44, s70, 1248
    v_add_u32 v4, s44, v4
    v_add_u32 v5, 1024, v4
    v_lshlrev_b32 v41, 2, v45
    v_sub_u32 v41, v44, v41
    s_add_u32 s44, s70, 2472
    v_lshl_add_u32 v6, v41, 3, s44
    s_add_u32 s44, s70, 2932
    v_lshl_add_u32 v7, v41, 2, s44
    v_lshrrev_b32 v41, 1, v45
    v_lshlrev_b32 v41, 8, v41
    v_lshl_add_u32 v41, v44, 4, v41
    v_and_b32 v42, 1, v45
    v_lshl_add_u32 v41, v42, 3, v41
    s_add_u32 s44, s70, 1078
    v_sub_u32 v32, s44, v41
    v_lshlrev_b32 v41, 8, v42
    v_lshl_add_u32 v41, v44, 4, v41
    s_add_u32 s44, s70, 556
    v_sub_u32 v33, s44, v41
    v_lshlrev_b32 v41, 7, v42
    v_add_u32 v41, s70, v41
    v_lshl_add_u32 v34, v44, 1, v41
    v_add_u32 v34, 2944, v34
    v_add_u32 v35, 32, v34
    s_mov_b32 exec_hi, 0
    v_lshl_add_u32 v34, v44, 2, v41
    v_add_u32 v34, 2496, v34
    v_add_u32 v35, 2, v34
    s_mov_b64 exec, -1
    s_add_u32 s44, s70, 58
    v_mov_b32 v36, s44
    s_add_u32 s44, s70, 1086
    v_writelane_b32 v36, s44, 32
    s_add_u32 s44, s70, 572
    v_writelane_b32 v36, s44, 63
    v_lshrrev_b32 v41, 1, v45
    v_lshlrev_b32 v41, 2, v41
    v_bfe_u32 v43, v1, 2, 2
    v_add_u32 v41, v41, v43
    v_mul_u32_u24 v37, 10368, v41
    v_lshl_add_u32 v37, v42, 6, v37
    v_and_b32 v41, 3, v1
    v_lshl_add_u32 v37, v41, 4, v37
    v_lshl_add_u32 v38, v44, 4, s70
    v_mul_u32_u24 v41, 1056, v45
    v_lshrrev_b32 v42, 1, v45
    v_lshl_add_u32 v41, v42, 7, v41
    v_min_u32 v41, 2688, v41
    v_add_u32 v38, v38, v41
    v_mov_b32 v39, 27648
    v_mov_b32 v98, 0x3f80
    v_mov_b32 v188, 0
    v_mov_b32 v189, 0
    v_mov_b32 v190, 0
    v_mov_b32 v191, 0
    v_mov_b32 v192, 0
    v_mov_b32 v193, 0
    v_mov_b32 v194, 0
    v_mov_b32 v195, 0
    v_mov_b32 v196, 0
    v_mov_b32 v197, 0
    v_mov_b32 v198, 0
    v_mov_b32 v199, 0
    s_mov_b32 m0, s70
    s_waitcnt vmcnt(6)
    v_lshlrev_b32 v46, 16, v46
    s_mov_b32 s44, 0x3fb8aa3b
    v_mul_f32 v41, s44, v46
    v_fma_f32 v42, v46, s44, -v41
    v_fmac_f32 v42, 0x32a57060, v46
    v_exp_f32 v41, v41
    v_mul_f32 v42, 0x3f317218, v42
    v_fmac_f32 v41, v41, v42
    v_cvt_pk_bf16_f32 v46, v41, v41
    v_and_b32 v46, 0xffff0000, v46
    v_lshlrev_b32 v47, 16, v47
    v_lshlrev_b32_e64 v60, 16, v48
    v_lshlrev_b32_e64 v61, 16, v49
    v_lshlrev_b32_e64 v62, 16, v50
    v_lshlrev_b32_e64 v63, 16, v51
    v_lshlrev_b32_e64 v64, 16, v52
    v_lshlrev_b32_e64 v65, 16, v53
    v_mul_f32 v92, v60, v46
    v_mul_f32 v93, v61, v46
    v_mul_f32 v62, v62, v46
    v_mul_f32 v63, v63, v46
    v_pk_mul_f32 v[70:71], v[62:63], v[64:65] op_sel_hi:[1,0]
    v_pk_fma_f32 v[68:69], v[62:63], v[64:65], v[70:71] op_sel:[1,1,0] op_sel_hi:[0,1,1] neg_lo:[0,1,0]
    v_mul_f32 v96, 0x3fa2f983, v93
    v_mul_f32 v94, 0x4138aa3b, v92
    v_fract_f32 v96, v96
    v_exp_f32 v94, v94
    v_cos_f32 v86, v96
    v_sin_f32 v87, v96
    v_mul_f32 v86, v86, v94
    v_mul_f32 v87, v87, v94
    v_mul_f32 v96, 0x3e22f983, v93
    v_mul_f32 v94, 0x3fb8aa3b, v92
    v_fract_f32 v96, v96
    v_exp_f32 v94, v94
    v_cos_f32 v72, v96
    v_sin_f32 v73, v96
    v_mul_f32 v72, v72, v94
    v_mul_f32 v73, v73, v94
    v_mul_f32 v96, 0x41a2f983, v93
    v_mul_f32 v94, 0x4338aa3b, v92
    v_fract_f32 v96, v96
    v_exp_f32 v94, v94
    v_cos_f32 v66, v96
    v_sin_f32 v67, v96
    v_mul_f32 v66, v66, v94
    v_mul_f32 v67, v67, v94
    s_mov_b32 s72, 0
    s_waitcnt lgkmcnt(0)
    .p2align 3
L_kgen:
    v_pk_mul_f32 v[70:71], v[68:69], v[86:87] op_sel_hi:[1,0]
    v_cvt_pk_bf16_f32 v132, v68, -v69
    v_pk_fma_f32 v[68:69], v[68:69], v[86:87], v[70:71] op_sel:[1,1,0] op_sel_hi:[0,1,1] neg_lo:[0,1,0]
    v_pk_mul_f32 v[70:71], v[68:69], v[86:87] op_sel_hi:[1,0]
    v_cvt_pk_bf16_f32 v133, v68, -v69
    v_pk_fma_f32 v[68:69], v[68:69], v[86:87], v[70:71] op_sel:[1,1,0] op_sel_hi:[0,1,1] neg_lo:[0,1,0]
    v_pk_mul_f32 v[70:71], v[68:69], v[86:87] op_sel_hi:[1,0]
    v_cvt_pk_bf16_f32 v134, v68, -v69
    v_pk_fma_f32 v[68:69], v[68:69], v[86:87], v[70:71] op_sel:[1,1,0] op_sel_hi:[0,1,1] neg_lo:[0,1,0]
    v_pk_mul_f32 v[70:71], v[68:69], v[86:87] op_sel_hi:[1,0]
    v_cvt_pk_bf16_f32 v135, v68, -v69
    v_pk_fma_f32 v[68:69], v[68:69], v[86:87], v[70:71] op_sel:[1,1,0] op_sel_hi:[0,1,1] neg_lo:[0,1,0]
    v_pk_mul_f32 v[70:71], v[68:69], v[86:87] op_sel_hi:[1,0]
    v_cvt_pk_bf16_f32 v136, v68, -v69
    v_pk_fma_f32 v[68:69], v[68:69], v[86:87], v[70:71] op_sel:[1,1,0] op_sel_hi:[0,1,1] neg_lo:[0,1,0]
    v_pk_mul_f32 v[70:71], v[68:69], v[86:87] op_sel_hi:[1,0]
    v_cvt_pk_bf16_f32 v137, v68, -v69
    v_pk_fma_f32 v[68:69], v[68:69], v[86:87], v[70:71] op_sel:[1,1,0] op_sel_hi:[0,1,1] neg_lo:[0,1,0]
    v_pk_mul_f32 v[70:71], v[68:69], v[86:87] op_sel_hi:[1,0]
    v_cvt_pk_bf16_f32 v138, v68, -v69
    v_pk_fma_f32 v[68:69], v[68:69], v[86:87], v[70:71] op_sel:[1,1,0] op_sel_hi:[0,1,1] neg_lo:[0,1,0]
    v_pk_mul_f32 v[70:71], v[68:69], v[86:87] op_sel_hi:[1,0]
    v_cvt_pk_bf16_f32 v139, v68, -v69
    v_pk_fma_f32 v[68:69], v[68:69], v[86:87], v[70:71] op_sel:[1,1,0] op_sel_hi:[0,1,1] neg_lo:[0,1,0]
    ds_write_addtid_b32 v132 offset:0
    ds_write_addtid_b32 v133 offset:288
    ds_write_addtid_b32 v134 offset:576
    ds_write_addtid_b32 v135 offset:864
    ds_write_addtid_b32 v136 offset:1152
    ds_write_addtid_b32 v137 offset:1440
    ds_write_addtid_b32 v138 offset:1728
    ds_write_addtid_b32 v139 offset:2016
    v_pk_mul_f32 v[70:71], v[68:69], v[86:87] op_sel_hi:[1,0]
    v_cvt_pk_bf16_f32 v140, v68, -v69
    v_pk_fma_f32 v[68:69], v[68:69], v[86:87], v[70:71] op_sel:[1,1,0] op_sel_hi:[0,1,1] neg_lo:[0,1,0]
    v_pk_mul_f32 v[70:71], v[68:69], v[86:87] op_sel_hi:[1,0]
    v_cvt_pk_bf16_f32 v141, v68, -v69
    v_pk_fma_f32 v[68:69], v[68:69], v[86:87], v[70:71] op_sel:[1,1,0] op_sel_hi:[0,1,1] neg_lo:[0,1,0]
    v_pk_mul_f32 v[70:71], v[68:69], v[86:87] op_sel_hi:[1,0]
    v_cvt_pk_bf16_f32 v142, v68, -v69
    v_pk_fma_f32 v[68:69], v[68:69], v[86:87], v[70:71] op_sel:[1,1,0] op_sel_hi:[0,1,1] neg_lo:[0,1,0]
    v_pk_mul_f32 v[70:71], v[68:69], v[86:87] op_sel_hi:[1,0]
    v_cvt_pk_bf16_f32 v143, v68, -v69
    v_pk_fma_f32 v[68:69], v[68:69], v[86:87], v[70:71] op_sel:[1,1,0] op_sel_hi:[0,1,1] neg_lo:[0,1,0]
    v_pk_mul_f32 v[70:71], v[68:69], v[86:87] op_sel_hi:[1,0]
    v_cvt_pk_bf16_f32 v144, v68, -v69
    v_pk_fma_f32 v[68:69], v[68:69], v[86:87], v[70:71] op_sel:[1,1,0] op_sel_hi:[0,1,1] neg_lo:[0,1,0]
    v_pk_mul_f32 v[70:71], v[68:69], v[86:87] op_sel_hi:[1,0]
    v_cvt_pk_bf16_f32 v145, v68, -v69
    v_pk_fma_f32 v[68:69], v[68:69], v[86:87], v[70:71] op_sel:[1,1,0] op_sel_hi:[0,1,1] neg_lo:[0,1,0]
    v_pk_mul_f32 v[70:71], v[68:69], v[86:87] op_sel_hi:[1,0]
    v_cvt_pk_bf16_f32 v146, v68, -v69
    v_pk_fma_f32 v[68:69], v[68:69], v[86:87], v[70:71] op_sel:[1,1,0] op_sel_hi:[0,1,1] neg_lo:[0,1,0]
    v_pk_mul_f32 v[70:71], v[72:73], v[72:73] op_sel_hi:[1,0]
    v_cvt_pk_bf16_f32 v147, v68, -v69
    v_pk_fma_f32 v[74:75], v[72:73], v[72:73], v[70:71] op_sel:[1,1,0] op_sel_hi:[0,1,1] neg_lo:[0,1,0]
    ds_write_addtid_b32 v140 offset:2304
    ds_write_addtid_b32 v141 offset:2592
    ds_write_addtid_b32 v142 offset:2880
    ds_write_addtid_b32 v143 offset:3168
    ds_write_addtid_b32 v144 offset:3456
    ds_write_addtid_b32 v145 offset:3744
    ds_write_addtid_b32 v146 offset:4032
    ds_write_addtid_b32 v147 offset:4320
    v_pk_mul_f32 v[70:71], v[74:75], v[72:73] op_sel_hi:[1,0]
    ds_read_b128 v[100:103], v2 offset:0
    ds_read_b128 v[104:107], v2 offset:64
    ds_read_b128 v[108:111], v2 offset:128
    ds_read_b128 v[112:115], v2 offset:192
    v_pk_fma_f32 v[76:77], v[74:75], v[72:73], v[70:71] op_sel:[1,1,0] op_sel_hi:[0,1,1] neg_lo:[0,1,0]
    v_pk_mul_f32 v[70:71], v[74:75], v[74:75] op_sel_hi:[1,0]
    v_cvt_pk_bf16_f32 v132, v72, v73
    v_pk_fma_f32 v[78:79], v[74:75], v[74:75], v[70:71] op_sel:[1,1,0] op_sel_hi:[0,1,1] neg_lo:[0,1,0]
    v_pk_mul_f32 v[70:71], v[78:79], v[72:73] op_sel_hi:[1,0]
    v_cvt_pk_bf16_f32 v133, v74, v75
    v_pk_fma_f32 v[80:81], v[78:79], v[72:73], v[70:71] op_sel:[1,1,0] op_sel_hi:[0,1,1] neg_lo:[0,1,0]
    v_pk_mul_f32 v[70:71], v[78:79], v[74:75] op_sel_hi:[1,0]
    v_cvt_pk_bf16_f32 v134, v76, v77
    v_pk_fma_f32 v[82:83], v[78:79], v[74:75], v[70:71] op_sel:[1,1,0] op_sel_hi:[0,1,1] neg_lo:[0,1,0]
    v_pk_mul_f32 v[70:71], v[78:79], v[76:77] op_sel_hi:[1,0]
    v_cvt_pk_bf16_f32 v135, v86, v87
    v_pk_fma_f32 v[84:85], v[78:79], v[76:77], v[70:71] op_sel:[1,1,0] op_sel_hi:[0,1,1] neg_lo:[0,1,0]
    v_pk_mul_f32 v[70:71], v[72:73], v[66:67] op_sel_hi:[1,0]
    v_cvt_pk_bf16_f32 v136, v78, v79
    v_pk_fma_f32 v[72:73], v[72:73], v[66:67], v[70:71] op_sel:[1,1,0] op_sel_hi:[0,1,1] neg_lo:[0,1,0]
    v_pk_mul_f32 v[70:71], v[74:75], v[66:67] op_sel_hi:[1,0]
    v_cvt_pk_bf16_f32 v137, v80, v81
    v_pk_fma_f32 v[74:75], v[74:75], v[66:67], v[70:71] op_sel:[1,1,0] op_sel_hi:[0,1,1] neg_lo:[0,1,0]
    v_pk_mul_f32 v[70:71], v[76:77], v[66:67] op_sel_hi:[1,0]
    v_cvt_pk_bf16_f32 v138, v82, v83
    v_pk_fma_f32 v[76:77], v[76:77], v[66:67], v[70:71] op_sel:[1,1,0] op_sel_hi:[0,1,1] neg_lo:[0,1,0]
    v_pk_mul_f32 v[70:71], v[86:87], v[66:67] op_sel_hi:[1,0]
    v_cvt_pk_bf16_f32 v139, v84, v85
    v_pk_fma_f32 v[86:87], v[86:87], v[66:67], v[70:71] op_sel:[1,1,0] op_sel_hi:[0,1,1] neg_lo:[0,1,0]
    ds_write_addtid_b32 v132 offset:0
    ds_write_addtid_b32 v133 offset:288
    ds_write_addtid_b32 v134 offset:576
    ds_write_addtid_b32 v135 offset:2016
    ds_write_addtid_b32 v136 offset:864
    ds_write_addtid_b32 v137 offset:1152
    ds_write_addtid_b32 v138 offset:1440
    ds_write_addtid_b32 v139 offset:1728
    v_pk_mul_f32 v[70:71], v[78:79], v[66:67] op_sel_hi:[1,0]
    v_cvt_pk_bf16_f32 v140, v72, v73
    v_pk_fma_f32 v[78:79], v[78:79], v[66:67], v[70:71] op_sel:[1,1,0] op_sel_hi:[0,1,1] neg_lo:[0,1,0]
    v_pk_mul_f32 v[70:71], v[80:81], v[66:67] op_sel_hi:[1,0]
    v_cvt_pk_bf16_f32 v141, v74, v75
    v_pk_fma_f32 v[80:81], v[80:81], v[66:67], v[70:71] op_sel:[1,1,0] op_sel_hi:[0,1,1] neg_lo:[0,1,0]
    v_pk_mul_f32 v[70:71], v[82:83], v[66:67] op_sel_hi:[1,0]
    v_cvt_pk_bf16_f32 v142, v76, v77
    v_pk_fma_f32 v[82:83], v[82:83], v[66:67], v[70:71] op_sel:[1,1,0] op_sel_hi:[0,1,1] neg_lo:[0,1,0]
    v_pk_mul_f32 v[70:71], v[84:85], v[66:67] op_sel_hi:[1,0]
    v_cvt_pk_bf16_f32 v143, v86, v87
    v_pk_fma_f32 v[84:85], v[84:85], v[66:67], v[70:71] op_sel:[1,1,0] op_sel_hi:[0,1,1] neg_lo:[0,1,0]
    v_pk_mul_f32 v[70:71], v[74:75], v[66:67] op_sel_hi:[1,0]
    v_cvt_pk_bf16_f32 v144, v78, v79
    v_pk_fma_f32 v[74:75], v[74:75], v[66:67], v[70:71] op_sel:[1,1,0] op_sel_hi:[0,1,1] neg_lo:[0,1,0]
    v_pk_mul_f32 v[70:71], v[86:87], v[66:67] op_sel_hi:[1,0]
    v_cvt_pk_bf16_f32 v145, v80, v81
    v_pk_fma_f32 v[86:87], v[86:87], v[66:67], v[70:71] op_sel:[1,1,0] op_sel_hi:[0,1,1] neg_lo:[0,1,0]
    v_pk_mul_f32 v[70:71], v[78:79], v[66:67] op_sel_hi:[1,0]
    v_cvt_pk_bf16_f32 v146, v82, v83
    v_pk_fma_f32 v[78:79], v[78:79], v[66:67], v[70:71] op_sel:[1,1,0] op_sel_hi:[0,1,1] neg_lo:[0,1,0]
    v_pk_mul_f32 v[70:71], v[82:83], v[66:67] op_sel_hi:[1,0]
    v_cvt_pk_bf16_f32 v147, v84, v85
    v_pk_fma_f32 v[82:83], v[82:83], v[66:67], v[70:71] op_sel:[1,1,0] op_sel_hi:[0,1,1] neg_lo:[0,1,0]
    ds_write_addtid_b32 v140 offset:2304
    ds_write_addtid_b32 v141 offset:2592
    ds_write_addtid_b32 v142 offset:2880
    ds_write_addtid_b32 v143 offset:4320
    ds_write_addtid_b32 v144 offset:3168
    ds_write_addtid_b32 v145 offset:3456
    ds_write_addtid_b32 v146 offset:3744
    ds_write_addtid_b32 v147 offset:4032
    v_pk_mul_f32 v[70:71], v[74:75], v[66:67] op_sel_hi:[1,0]
    ds_read_b128 v[116:119], v2 offset:0
    ds_read_b128 v[120:123], v2 offset:64
    ds_read_b128 v[124:127], v2 offset:128
    ds_read_b128 v[128:131], v2 offset:192
    v_cvt_pk_bf16_f32 v132, v74, v75
    v_pk_fma_f32 v[74:75], v[74:75], v[66:67], v[70:71] op_sel:[1,1,0] op_sel_hi:[0,1,1] neg_lo:[0,1,0]
    v_pk_mul_f32 v[70:71], v[86:87], v[66:67] op_sel_hi:[1,0]
    v_cvt_pk_bf16_f32 v133, v86, v87
    v_pk_fma_f32 v[86:87], v[86:87], v[66:67], v[70:71] op_sel:[1,1,0] op_sel_hi:[0,1,1] neg_lo:[0,1,0]
    v_pk_mul_f32 v[70:71], v[78:79], v[66:67] op_sel_hi:[1,0]
    v_cvt_pk_bf16_f32 v134, v78, v79
    v_pk_fma_f32 v[78:79], v[78:79], v[66:67], v[70:71] op_sel:[1,1,0] op_sel_hi:[0,1,1] neg_lo:[0,1,0]
    v_pk_mul_f32 v[70:71], v[82:83], v[66:67] op_sel_hi:[1,0]
    v_cvt_pk_bf16_f32 v135, v82, v83
    v_pk_fma_f32 v[82:83], v[82:83], v[66:67], v[70:71] op_sel:[1,1,0] op_sel_hi:[0,1,1] neg_lo:[0,1,0]
    v_pk_mul_f32 v[70:71], v[86:87], v[66:67] op_sel_hi:[1,0]
    v_cvt_pk_bf16_f32 v136, v86, v87
    v_pk_fma_f32 v[86:87], v[86:87], v[66:67], v[70:71] op_sel:[1,1,0] op_sel_hi:[0,1,1] neg_lo:[0,1,0]
    v_pk_mul_f32 v[70:71], v[78:79], v[66:67] op_sel_hi:[1,0]
    v_cvt_pk_bf16_f32 v137, v78, v79
    v_pk_fma_f32 v[78:79], v[78:79], v[66:67], v[70:71] op_sel:[1,1,0] op_sel_hi:[0,1,1] neg_lo:[0,1,0]
    v_pk_mul_f32 v[70:71], v[86:87], v[66:67] op_sel_hi:[1,0]
    v_cvt_pk_bf16_f32 v138, v74, v75
    v_cvt_pk_bf16_f32 v139, v82, v83
    s_waitcnt lgkmcnt(0)
    s_nop 0
    v_mfma_f32_16x16x32_bf16 v[188:191], v[116:119], v[100:103], v[188:191]
    ds_write_addtid_b32 v132 offset:0
    ds_write_addtid_b32 v98 offset:2304
    v_mfma_f32_16x16x32_bf16 v[188:191], v[120:123], v[104:107], v[188:191]
    ds_write_addtid_b32 v133 offset:864
    ds_write_addtid_b32 v134 offset:288
    v_mfma_f32_16x16x32_bf16 v[188:191], v[124:127], v[108:111], v[188:191]
    ds_write_addtid_b32 v135 offset:576
    ds_write_addtid_b32 v136 offset:2016
    v_mfma_f32_16x16x32_bf16 v[188:191], v[128:131], v[112:115], v[188:191]
    ds_write_addtid_b32 v137 offset:1440
    ds_write_addtid_b32 v138 offset:1152
    ds_write_addtid_b32 v139 offset:1728
    ds_read_b128 v[116:119], v2 offset:0
    ds_read_b128 v[120:123], v2 offset:64
    ds_read_b128 v[124:127], v2 offset:128
    ds_read_b128 v[128:131], v2 offset:192
    v_cvt_pk_bf16_f32 v140, v86, v87
    v_pk_fma_f32 v[86:87], v[86:87], v[66:67], v[70:71] op_sel:[1,1,0] op_sel_hi:[0,1,1] neg_lo:[0,1,0]
    v_pk_mul_f32 v[70:71], v[78:79], v[66:67] op_sel_hi:[1,0]
    v_cvt_pk_bf16_f32 v141, v78, v79
    v_pk_fma_f32 v[78:79], v[78:79], v[66:67], v[70:71] op_sel:[1,1,0] op_sel_hi:[0,1,1] neg_lo:[0,1,0]
    v_pk_mul_f32 v[70:71], v[86:87], v[66:67] op_sel_hi:[1,0]
    v_cvt_pk_bf16_f32 v142, v86, v87
    v_pk_fma_f32 v[86:87], v[86:87], v[66:67], v[70:71] op_sel:[1,1,0] op_sel_hi:[0,1,1] neg_lo:[0,1,0]
    v_pk_mul_f32 v[70:71], v[78:79], v[66:67] op_sel_hi:[1,0]
    v_cvt_pk_bf16_f32 v143, v78, v79
    v_pk_fma_f32 v[78:79], v[78:79], v[66:67], v[70:71] op_sel:[1,1,0] op_sel_hi:[0,1,1] neg_lo:[0,1,0]
    v_pk_mul_f32 v[70:71], v[86:87], v[66:67] op_sel_hi:[1,0]
    v_cvt_pk_bf16_f32 v144, v86, v87
    v_pk_fma_f32 v[86:87], v[86:87], v[66:67], v[70:71] op_sel:[1,1,0] op_sel_hi:[0,1,1] neg_lo:[0,1,0]
    v_pk_mul_f32 v[70:71], v[78:79], v[66:67] op_sel_hi:[1,0]
    v_cvt_pk_bf16_f32 v145, v78, v79
    v_pk_fma_f32 v[78:79], v[78:79], v[66:67], v[70:71] op_sel:[1,1,0] op_sel_hi:[0,1,1] neg_lo:[0,1,0]
    v_pk_mul_f32 v[70:71], v[86:87], v[66:67] op_sel_hi:[1,0]
    v_cvt_pk_bf16_f32 v146, v86, v87
    v_pk_fma_f32 v[86:87], v[86:87], v[66:67], v[70:71] op_sel:[1,1,0] op_sel_hi:[0,1,1] neg_lo:[0,1,0]
    v_cvt_pk_bf16_f32 v147, v78, v79
    s_waitcnt lgkmcnt(0)
    s_nop 0
    v_mfma_f32_16x16x32_bf16 v[192:195], v[116:119], v[100:103], v[192:195]
    ds_write_addtid_b32 v140 offset:288
    ds_write_addtid_b32 v141 offset:0
    v_mfma_f32_16x16x32_bf16 v[192:195], v[120:123], v[104:107], v[192:195]
    ds_write_addtid_b32 v142 offset:864
    ds_write_addtid_b32 v143 offset:576
    v_mfma_f32_16x16x32_bf16 v[192:195], v[124:127], v[108:111], v[192:195]
    ds_write_addtid_b32 v144 offset:1440
    ds_write_addtid_b32 v145 offset:1152
    v_mfma_f32_16x16x32_bf16 v[192:195], v[128:131], v[112:115], v[192:195]
    ds_write_addtid_b32 v146 offset:2016
    ds_write_addtid_b32 v147 offset:1728
    v_pk_mul_f32 v[70:71], v[86:87], v[66:67] op_sel_hi:[1,0]
    v_cvt_pk_bf16_f32 v132, v86, v87
    v_pk_fma_f32 v[86:87], v[86:87], v[66:67], v[70:71] op_sel:[1,1,0] op_sel_hi:[0,1,1] neg_lo:[0,1,0]
    v_pk_mul_f32 v[70:71], v[86:87], v[66:67] op_sel_hi:[1,0]
    v_cvt_pk_bf16_f32 v133, v86, v87
    v_pk_fma_f32 v[86:87], v[86:87], v[66:67], v[70:71] op_sel:[1,1,0] op_sel_hi:[0,1,1] neg_lo:[0,1,0]
    v_pk_mul_f32 v[70:71], v[86:87], v[66:67] op_sel_hi:[1,0]
    v_cvt_pk_bf16_f32 v134, v86, v87
    v_pk_fma_f32 v[86:87], v[86:87], v[66:67], v[70:71] op_sel:[1,1,0] op_sel_hi:[0,1,1] neg_lo:[0,1,0]
    v_pk_mul_f32 v[70:71], v[86:87], v[66:67] op_sel_hi:[1,0]
    v_cvt_pk_bf16_f32 v135, v86, v87
    v_pk_fma_f32 v[86:87], v[86:87], v[66:67], v[70:71] op_sel:[1,1,0] op_sel_hi:[0,1,1] neg_lo:[0,1,0]
    v_pk_mul_f32 v[70:71], v[86:87], v[66:67] op_sel_hi:[1,0]
    v_cvt_pk_bf16_f32 v136, v86, v87
    v_pk_fma_f32 v[86:87], v[86:87], v[66:67], v[70:71] op_sel:[1,1,0] op_sel_hi:[0,1,1] neg_lo:[0,1,0]
    v_pk_mul_f32 v[70:71], v[86:87], v[66:67] op_sel_hi:[1,0]
    v_cvt_pk_bf16_f32 v137, v86, v87
    v_pk_fma_f32 v[86:87], v[86:87], v[66:67], v[70:71] op_sel:[1,1,0] op_sel_hi:[0,1,1] neg_lo:[0,1,0]
    v_pk_mul_f32 v[70:71], v[86:87], v[66:67] op_sel_hi:[1,0]
    v_cvt_pk_bf16_f32 v138, v86, v87
    v_pk_fma_f32 v[86:87], v[86:87], v[66:67], v[70:71] op_sel:[1,1,0] op_sel_hi:[0,1,1] neg_lo:[0,1,0]
    v_cvt_pk_bf16_f32 v139, v86, v87
    s_add_u32 s72, s72, 1
    s_cmp_lt_u32 s72, 3
    ds_write_addtid_b32 v132 offset:2304
    ds_write_addtid_b32 v133 offset:2592
    ds_write_addtid_b32 v134 offset:2880
    ds_write_addtid_b32 v135 offset:3168
    ds_write_addtid_b32 v136 offset:3456
    ds_write_addtid_b32 v137 offset:3744
    ds_write_addtid_b32 v138 offset:4032
    ds_write_addtid_b32 v139 offset:4320
    ds_read_b128 v[116:119], v2 offset:0
    ds_read_b128 v[120:123], v2 offset:64
    ds_read_b128 v[124:127], v2 offset:128
    ds_read_b128 v[128:131], v2 offset:192
    s_cbranch_scc0 L_kgen_done
    s_waitcnt vmcnt(0)
    v_and_b32 v60, 0xffff0000, v48
    v_lshlrev_b32_e64 v48, 16, v54
    v_and_b32 v61, 0xffff0000, v49
    v_lshlrev_b32_e64 v49, 16, v55
    v_and_b32 v62, 0xffff0000, v50
    v_lshlrev_b32_e64 v50, 16, v56
    v_and_b32 v63, 0xffff0000, v51
    v_lshlrev_b32_e64 v51, 16, v57
    v_and_b32 v64, 0xffff0000, v52
    v_lshlrev_b32_e64 v52, 16, v58
    v_and_b32 v65, 0xffff0000, v53
    v_lshlrev_b32_e64 v53, 16, v59
    v_mul_f32 v92, v60, v46
    v_mul_f32 v93, v61, v46
    v_mul_f32 v62, v62, v46
    v_mul_f32 v63, v63, v46
    v_pk_mul_f32 v[70:71], v[62:63], v[64:65] op_sel_hi:[1,0]
    v_pk_fma_f32 v[68:69], v[62:63], v[64:65], v[70:71] op_sel:[1,1,0] op_sel_hi:[0,1,1] neg_lo:[0,1,0]
    s_waitcnt lgkmcnt(0)
    v_mfma_f32_16x16x32_bf16 v[196:199], v[116:119], v[100:103], v[196:199]
    v_mfma_f32_16x16x32_bf16 v[196:199], v[120:123], v[104:107], v[196:199]
    v_mul_f32 v96, 0x3fa2f983, v93
    v_mul_f32 v94, 0x4138aa3b, v92
    v_fract_f32 v96, v96
    v_exp_f32 v94, v94
    v_cos_f32 v86, v96
    v_sin_f32 v87, v96
    v_mfma_f32_16x16x32_bf16 v[196:199], v[124:127], v[108:111], v[196:199]
    v_mul_f32 v86, v86, v94
    v_mul_f32 v87, v87, v94
    v_mfma_f32_16x16x32_bf16 v[196:199], v[128:131], v[112:115], v[196:199]
    v_mul_f32 v96, 0x3e22f983, v93
    v_mul_f32 v94, 0x3fb8aa3b, v92
    v_fract_f32 v96, v96
    v_exp_f32 v94, v94
    v_cos_f32 v72, v96
    v_sin_f32 v73, v96
    v_mul_f32 v72, v72, v94
    v_mul_f32 v73, v73, v94
    v_mul_f32 v96, 0x41a2f983, v93
    v_mul_f32 v94, 0x4338aa3b, v92
    v_fract_f32 v96, v96
    v_exp_f32 v94, v94
    v_cos_f32 v66, v96
    v_sin_f32 v67, v96
    v_mul_f32 v66, v66, v94
    v_mul_f32 v67, v67, v94
    s_branch L_kgen
L_kgen_done:
    s_setprio 1
    v_mov_b32 v72, 0
    v_mov_b32 v73, 0
    v_mov_b32 v74, 0
    v_mov_b32 v75, 0
    ds_write_b128 v38, v[72:75]
    ds_read_b32 v40, v39 offset:0
    s_waitcnt lgkmcnt(5)
    v_mfma_f32_16x16x32_bf16 v[196:199], v[116:119], v[100:103], v[196:199]
    s_waitcnt lgkmcnt(4)
    v_mfma_f32_16x16x32_bf16 v[196:199], v[120:123], v[104:107], v[196:199]
    s_waitcnt lgkmcnt(3)
    v_mfma_f32_16x16x32_bf16 v[196:199], v[124:127], v[108:111], v[196:199]
    s_waitcnt lgkmcnt(2)
    v_mfma_f32_16x16x32_bf16 v[196:199], v[128:131], v[112:115], v[196:199]
    v_cvt_pk_bf16_f32 v76, v191, v190
    v_cvt_pk_bf16_f32 v77, v189, v188
    v_cvt_pk_bf16_f32 v78, v190, v189
    v_cvt_pk_bf16_f32 v79, v195, v195
    v_cvt_pk_bf16_f32 v80, v195, v194
    v_cvt_pk_bf16_f32 v81, v193, v193
    v_cvt_pk_bf16_f32 v82, v193, v192
    v_cvt_pk_bf16_f32 v83, v194, v193
    v_add_f32 v86, v192, v47
    ds_write_b64 v32, v[76:77] offset:1218
    ds_write_b16 v32, v76
    ds_write_b32 v32, v78 offset:2
    ds_write_b16_d16_hi v32, v77 offset:6
    v_cvt_pk_bf16_f32 v86, v86, v86
    v_cvt_pk_bf16_f32 v84, v196, v197
    v_cvt_pk_bf16_f32 v85, v198, v199
    s_mov_b32 exec_hi, 0
    v_mov_b32 v86, v79
    v_add_u32 v41, 1220, v33
    ds_write2_b32 v33, v79, v80 offset0:0 offset1:1
    ds_write2_b32 v33, v81, v82 offset0:2 offset1:3
    ds_write_b16 v33, v79 offset:1218
    ds_write2_b32 v41, v79, v83 offset0:0 offset1:1
    ds_write_b32 v41, v81 offset:8
    ds_write_b16_d16_hi v41, v82 offset:12
    s_mov_b32 exec_lo, 0
    s_mov_b32 exec_hi, 0x80000000
    v_mov_b32 v86, v76
    s_mov_b32 exec_lo, 0x80000000
    s_mov_b32 exec_hi, 0x80000001
    ds_write_b16 v36, v86
    ds_write_b16 v36, v86 offset:1218
    s_mov_b64 exec, -1
    ds_write_b16 v34, v84
    ds_write_b16_d16_hi v35, v84
    ds_write_b16 v34, v85 offset:64
    ds_write_b16_d16_hi v35, v85 offset:64
    v_mov_b32 v41, s70
    s_waitcnt lgkmcnt(0)
    v_readfirstlane_b32 s44, v40
    s_nop 0
    s_cmp_ge_u32 s44, 5
    s_cbranch_scc1 L_ok_12
    s_waitcnt lgkmcnt(0)
    s_mov_b32 s48, 0
L_spin_13:
    ds_read_b32 v40, v39 offset:0
    s_add_u32 s48, s48, 1
    s_waitcnt lgkmcnt(0)
    v_readfirstlane_b32 s44, v40
    s_nop 0
    s_cmp_ge_u32 s44, 5
    s_cbranch_scc1 L_spun_14
    s_cmp_lt_u32 s48, 400000
    s_cbranch_scc1 L_spin_13
L_spun_14:
L_ok_12:
    ds_read2_b32 v[28:29], v253 offset0:64 offset1:66
    ds_read2_b32 v[30:31], v253 offset0:68 offset1:70
    ds_read2_b32 v[8:9], v252 offset0:0 offset1:2
    ds_read2_b32 v[10:11], v252 offset0:4 offset1:6
    ds_read2_b32 v[12:13], v252 offset0:64 offset1:66
    ds_read2_b32 v[14:15], v252 offset0:68 offset1:70
    ds_read2_b32 v[16:17], v252 offset0:128 offset1:130
    ds_read2_b32 v[18:19], v252 offset0:132 offset1:134
    ds_read2_b32 v[20:21], v252 offset0:192 offset1:194
    ds_read2_b32 v[22:23], v252 offset0:196 offset1:198
    ds_read2_b32 v[24:25], v253 offset0:0 offset1:2
    ds_read2_b32 v[26:27], v253 offset0:4 offset1:6
    ds_read_u16 v42, v41 offset:2750
    ds_read2_b32 v[76:77], v4 offset0:144 offset1:145
    ds_read2_b32 v[78:79], v4 offset0:146 offset1:147
    ds_read2_b32 v[108:109], v4 offset0:16 offset1:17
    ds_read2_b32 v[110:111], v4 offset0:18 offset1:19
    ds_read2_b32 v[72:73], v4 offset0:160 offset1:161
    ds_read2_b32 v[74:75], v4 offset0:162 offset1:163
    ds_read2_b32 v[104:105], v4 offset0:32 offset1:33
    ds_read2_b32 v[106:107], v4 offset0:34 offset1:35
    ds_read2_b32 v[68:69], v4 offset0:176 offset1:177
    ds_read2_b32 v[70:71], v4 offset0:178 offset1:179
    ds_read2_b32 v[100:101], v4 offset0:48 offset1:49
    ds_read2_b32 v[102:103], v4 offset0:50 offset1:51
    ds_read2_b32 v[64:65], v4 offset0:192 offset1:193
    ds_read2_b32 v[66:67], v4 offset0:194 offset1:195
    ds_read2_b32 v[96:97], v4 offset0:64 offset1:65
    ds_read2_b32 v[98:99], v4 offset0:66 offset1:67
    ds_read2_b32 v[60:61], v4 offset0:208 offset1:209
    ds_read2_b32 v[62:63], v4 offset0:210 offset1:211
    ds_read2_b32 v[92:93], v4 offset0:80 offset1:81
    ds_read2_b32 v[94:95], v4 offset0:82 offset1:83
    ds_read2_b32 v[56:57], v4 offset0:224 offset1:225
    ds_read2_b32 v[58:59], v4 offset0:226 offset1:227
    ds_read2_b32 v[88:89], v4 offset0:96 offset1:97
    ds_read2_b32 v[90:91], v4 offset0:98 offset1:99
    ds_read2_b32 v[52:53], v4 offset0:240 offset1:241
    ds_read2_b32 v[54:55], v4 offset0:242 offset1:243
    ds_read2_b32 v[84:85], v4 offset0:112 offset1:113
    ds_read2_b32 v[86:87], v4 offset0:114 offset1:115
    ds_read2_b32 v[48:49], v5 offset0:0 offset1:1
    ds_read2_b32 v[50:51], v5 offset0:2 offset1:3
    ds_read2_b32 v[80:81], v4 offset0:128 offset1:129
    ds_read2_b32 v[82:83], v4 offset0:130 offset1:131
    ds_read2_b32 v[112:113], v4 offset0:0 offset1:1
    ds_read2_b32 v[114:115], v4 offset0:2 offset1:3
    ds_read2_b64 v[116:119], v6 offset0:2 offset1:3
    ds_read2_b64 v[124:127], v6 offset0:18 offset1:19
    ds_read2_b64 v[132:135], v6 offset0:34 offset1:35
    ds_read2_b64 v[120:123], v6 offset0:0 offset1:1
    ds_read2_b64 v[128:131], v6 offset0:16 offset1:17
    ds_read2_b64 v[136:139], v6 offset0:32 offset1:33
    ds_read2_b32 v[140:141], v7 offset0:0 offset1:1
    ds_read2_b32 v[142:143], v7 offset0:2 offset1:3
    ds_read2_b32 v[144:145], v7 offset0:16 offset1:17
    ds_read2_b32 v[146:147], v7 offset0:18 offset1:19
    ds_read2_b32 v[148:149], v7 offset0:32 offset1:33
    ds_read2_b32 v[150:151], v7 offset0:34 offset1:35
    ds_read2_b32 v[152:153], v7 offset0:48 offset1:49
    ds_read2_b32 v[154:155], v7 offset0:50 offset1:51
    s_waitcnt lgkmcnt(15)
    v_lshl_or_b32 v42, v42, 16, v42
    v_and_b32 v28, v28, v42
    v_and_b32 v29, v29, v42
    v_and_b32 v30, v30, v42
    v_and_b32 v31, v31, v42
    s_setprio 1
    s_waitcnt lgkmcnt(0)
    s_mov_b32 s48, 0
L_spin_15:
    ds_read_b32 v40, v39 offset:20
    s_add_u32 s48, s48, 1
    s_waitcnt lgkmcnt(0)
    v_readfirstlane_b32 s44, v40
    s_nop 0
    s_cmp_ge_u32 s44, 1
    s_cbranch_scc1 L_spun_16
    s_cmp_lt_u32 s48, 400000
    s_cbranch_scc1 L_spin_15
L_spun_16:
    ds_read_b128 v[224:227], v3 offset:32
    ds_read_b128 v[228:231], v3 offset:96
    ds_read_b128 v[232:235], v3 offset:160
    ds_read_b128 v[236:239], v3 offset:224
    ds_read_b128 v[240:243], v3 offset:288
    ds_read_b128 v[244:247], v3 offset:352
    s_waitcnt lgkmcnt(5)
    v_mfma_f32_16x16x32_bf16 v[156:159], v[76:79], v[224:227], 0
    v_mfma_f32_16x16x32_bf16 v[160:163], v[108:111], v[224:227], 0
    s_waitcnt lgkmcnt(4)
    v_mfma_f32_16x16x32_bf16 v[156:159], v[72:75], v[228:231], v[156:159]
    ds_read_b128 v[224:227], v3 offset:416
    v_mfma_f32_16x16x32_bf16 v[160:163], v[104:107], v[228:231], v[160:163]
    s_waitcnt lgkmcnt(4)
    v_mfma_f32_16x16x32_bf16 v[156:159], v[68:71], v[232:235], v[156:159]
    ds_read_b128 v[228:231], v3 offset:480
    v_mfma_f32_16x16x32_bf16 v[160:163], v[100:103], v[232:235], v[160:163]
    ds_read_b128 v[248:251], v3 offset:464
    s_waitcnt lgkmcnt(5)
    v_mfma_f32_16x16x32_bf16 v[156:159], v[64:67], v[236:239], v[156:159]
    ds_read_b128 v[232:235], v3 offset:544
    v_mfma_f32_16x16x32_bf16 v[160:163], v[96:99], v[236:239], v[160:163]
    s_waitcnt lgkmcnt(5)
    v_mfma_f32_16x16x32_bf16 v[156:159], v[60:63], v[240:243], v[156:159]
    ds_read_b128 v[236:239], v3 offset:608
    v_mfma_f32_16x16x32_bf16 v[160:163], v[92:95], v[240:243], v[160:163]
    s_waitcnt lgkmcnt(5)
    v_mfma_f32_16x16x32_bf16 v[156:159], v[56:59], v[244:247], v[156:159]
    ds_read_b128 v[240:243], v3 offset:672
    v_mfma_f32_16x16x32_bf16 v[160:163], v[88:91], v[244:247], v[160:163]
    s_waitcnt lgkmcnt(5)
    v_mfma_f32_16x16x32_bf16 v[156:159], v[52:55], v[224:227], v[156:159]
    ds_read_b128 v[244:247], v3 offset:736
    v_mfma_f32_16x16x32_bf16 v[160:163], v[84:87], v[224:227], v[160:163]
    s_waitcnt lgkmcnt(5)
    v_mfma_f32_16x16x32_bf16 v[188:191], v[228:231], v[8:11], 0
    ds_read_b128 v[224:227], v3 offset:800
    v_mfma_f32_16x16x32_bf16 v[192:195], v[228:231], v[12:15], 0
    v_mfma_f32_16x16x32_bf16 v[196:199], v[228:231], v[16:19], 0
    s_waitcnt lgkmcnt(5)
    v_mfma_f32_16x16x32_bf16 v[200:203], v[248:251], v[12:15], 0
    v_mfma_f32_16x16x32_bf16 v[204:207], v[228:231], v[20:23], 0
    v_mfma_f32_16x16x32_bf16 v[208:211], v[248:251], v[24:27], 0
    v_mfma_f32_16x16x32_bf16 v[156:159], v[48:51], v[228:231], v[156:159]
    v_mfma_f32_16x16x32_bf16 v[160:163], v[80:83], v[228:231], v[160:163]
    v_mfma_f32_16x16x32_bf16 v[164:167], v[112:115], v[228:231], 0
    v_mfma_f32_16x16x32_bf16 v[172:175], v[28:31], v[228:231], 0
    s_waitcnt lgkmcnt(4)
    v_mfma_f32_16x16x32_bf16 v[160:163], v[76:79], v[232:235], v[160:163]
    ds_read_b128 v[228:231], v3 offset:864
    v_cvt_pk_bf16_f32 v212, v189, v193
    v_mfma_f32_16x16x32_bf16 v[164:167], v[108:111], v[232:235], v[164:167]
    v_cvt_pk_bf16_f32 v213, v197, v201
    v_cvt_pk_bf16_f32 v214, v188, v192
    s_waitcnt lgkmcnt(4)
    v_mfma_f32_16x16x32_bf16 v[160:163], v[72:75], v[236:239], v[160:163]
    v_cvt_pk_bf16_f32 v215, v196, v200
    v_cvt_pk_bf16_f32 v216, v191, v195
    v_mfma_f32_16x16x32_bf16 v[164:167], v[104:107], v[236:239], v[164:167]
    v_cvt_pk_bf16_f32 v217, v199, v203
    v_cvt_pk_bf16_f32 v218, v190, v194
    s_waitcnt lgkmcnt(3)
    v_mfma_f32_16x16x32_bf16 v[160:163], v[68:71], v[240:243], v[160:163]
    v_cvt_pk_bf16_f32 v219, v198, v202
    ds_read_b128 v[232:235], v3 offset:928
    v_mfma_f32_16x16x32_bf16 v[164:167], v[100:103], v[240:243], v[164:167]
    v_cvt_pk_bf16_f32 v220, v207, v211
    v_cvt_pk_bf16_f32 v221, v206, v210
    v_mfma_f32_16x16x32_bf16 v[164:167], v[212:215], v[116:119], v[164:167]
    v_cvt_pk_bf16_f32 v222, v205, v209
    v_cvt_pk_bf16_f32 v223, v204, v208
    v_mfma_f32_16x16x32_bf16 v[168:171], v[212:215], v[124:127], 0
    ds_read_b128 v[236:239], v3 offset:992
    ds_read_b128 v[248:251], v3 offset:976
    v_mfma_f32_16x16x32_bf16 v[172:175], v[212:215], v[132:135], v[172:175]
    ds_read_b128 v[240:243], v3 offset:1056
    s_waitcnt lgkmcnt(6)
    v_mfma_f32_16x16x32_bf16 v[160:163], v[64:67], v[244:247], v[160:163]
    v_mfma_f32_16x16x32_bf16 v[164:167], v[96:99], v[244:247], v[164:167]
    v_mfma_f32_16x16x32_bf16 v[164:167], v[216:219], v[120:123], v[164:167]
    ds_read_b128 v[244:247], v3 offset:1120
    v_mfma_f32_16x16x32_bf16 v[168:171], v[216:219], v[128:131], v[168:171]
    v_mfma_f32_16x16x32_bf16 v[172:175], v[216:219], v[136:139], v[172:175]
    s_waitcnt lgkmcnt(6)
    v_mfma_f32_16x16x32_bf16 v[160:163], v[60:63], v[224:227], v[160:163]
    v_cvt_pk_bf16_f32 v156, v156, v157
    v_cvt_pk_bf16_f32 v157, v158, v159
    v_mfma_f32_16x16x32_bf16 v[164:167], v[92:95], v[224:227], v[164:167]
    v_mfma_f32_16x16x32_bf16 v[172:175], v[220:223], v[140:143], v[172:175]
    ds_read_b128 v[224:227], v3 offset:1184
    v_mfma_f32_16x16x32_bf16 v[176:179], v[220:223], v[144:147], 0
    v_mfma_f32_16x16x32_bf16 v[180:183], v[220:223], v[148:151], 0
    v_mfma_f32_16x16x32_bf16 v[184:187], v[220:223], v[152:155], 0
    s_waitcnt lgkmcnt(6)
    v_mfma_f32_16x16x32_bf16 v[160:163], v[56:59], v[228:231], v[160:163]
    v_mfma_f32_16x16x32_bf16 v[164:167], v[88:91], v[228:231], v[164:167]
    s_waitcnt lgkmcnt(5)
    v_mfma_f32_16x16x32_bf16 v[160:163], v[52:55], v[232:235], v[160:163]
    ds_read_b128 v[228:231], v3 offset:1248
    v_mfma_f32_16x16x32_bf16 v[164:167], v[84:87], v[232:235], v[164:167]
    s_waitcnt lgkmcnt(5)
    v_mfma_f32_16x16x32_bf16 v[188:191], v[236:239], v[8:11], 0
    ds_read_b128 v[232:235], v3 offset:1312
    v_mfma_f32_16x16x32_bf16 v[192:195], v[236:239], v[12:15], 0
    v_mfma_f32_16x16x32_bf16 v[196:199], v[236:239], v[16:19], 0
    s_waitcnt lgkmcnt(5)
    v_mfma_f32_16x16x32_bf16 v[200:203], v[248:251], v[12:15], 0
    v_mfma_f32_16x16x32_bf16 v[204:207], v[236:239], v[20:23], 0
    v_mfma_f32_16x16x32_bf16 v[208:211], v[248:251], v[24:27], 0
    v_mfma_f32_16x16x32_bf16 v[160:163], v[48:51], v[236:239], v[160:163]
    v_mfma_f32_16x16x32_bf16 v[164:167], v[80:83], v[236:239], v[164:167]
    v_mfma_f32_16x16x32_bf16 v[168:171], v[112:115], v[236:239], v[168:171]
    v_mfma_f32_16x16x32_bf16 v[176:179], v[28:31], v[236:239], v[176:179]
    s_waitcnt lgkmcnt(4)
    v_mfma_f32_16x16x32_bf16 v[164:167], v[76:79], v[240:243], v[164:167]
    ds_read_b128 v[236:239], v3 offset:1376
    v_cvt_pk_bf16_f32 v212, v189, v193
    v_mfma_f32_16x16x32_bf16 v[168:171], v[108:111], v[240:243], v[168:171]
    v_cvt_pk_bf16_f32 v213, v197, v201
    v_cvt_pk_bf16_f32 v214, v188, v192
    s_waitcnt lgkmcnt(4)
    v_mfma_f32_16x16x32_bf16 v[164:167], v[72:75], v[244:247], v[164:167]
    v_cvt_pk_bf16_f32 v215, v196, v200
    v_cvt_pk_bf16_f32 v216, v191, v195
    v_mfma_f32_16x16x32_bf16 v[168:171], v[104:107], v[244:247], v[168:171]
    v_cvt_pk_bf16_f32 v217, v199, v203
    v_cvt_pk_bf16_f32 v218, v190, v194
    s_waitcnt lgkmcnt(3)
    v_mfma_f32_16x16x32_bf16 v[164:167], v[68:71], v[224:227], v[164:167]
    v_cvt_pk_bf16_f32 v219, v198, v202
    ds_read_b128 v[240:243], v3 offset:1440
    v_mfma_f32_16x16x32_bf16 v[168:171], v[100:103], v[224:227], v[168:171]
    v_cvt_pk_bf16_f32 v220, v207, v211
    v_cvt_pk_bf16_f32 v221, v206, v210
    v_mfma_f32_16x16x32_bf16 v[168:171], v[212:215], v[116:119], v[168:171]
    v_cvt_pk_bf16_f32 v222, v205, v209
    v_cvt_pk_bf16_f32 v223, v204, v208
    v_mfma_f32_16x16x32_bf16 v[172:175], v[212:215], v[124:127], v[172:175]
    ds_read_b128 v[244:247], v3 offset:1504
    ds_read_b128 v[248:251], v3 offset:1488
    v_mfma_f32_16x16x32_bf16 v[176:179], v[212:215], v[132:135], v[176:179]
    ds_read_b128 v[224:227], v3 offset:1568
    s_waitcnt lgkmcnt(6)
    v_mfma_f32_16x16x32_bf16 v[164:167], v[64:67], v[228:231], v[164:167]
    v_mfma_f32_16x16x32_bf16 v[168:171], v[96:99], v[228:231], v[168:171]
    v_mfma_f32_16x16x32_bf16 v[168:171], v[216:219], v[120:123], v[168:171]
    ds_read_b128 v[228:231], v3 offset:1632
    v_mfma_f32_16x16x32_bf16 v[172:175], v[216:219], v[128:131], v[172:175]
    v_mfma_f32_16x16x32_bf16 v[176:179], v[216:219], v[136:139], v[176:179]
    s_waitcnt lgkmcnt(6)
    v_mfma_f32_16x16x32_bf16 v[164:167], v[60:63], v[232:235], v[164:167]
    v_cvt_pk_bf16_f32 v158, v160, v161
    v_cvt_pk_bf16_f32 v159, v162, v163
    v_mfma_f32_16x16x32_bf16 v[168:171], v[92:95], v[232:235], v[168:171]
    v_mfma_f32_16x16x32_bf16 v[176:179], v[220:223], v[140:143], v[176:179]
    ds_read_b128 v[232:235], v3 offset:1696
    v_permlane32_swap_b32 v156, v158
    v_mfma_f32_16x16x32_bf16 v[180:183], v[220:223], v[144:147], v[180:183]
    v_permlane32_swap_b32 v157, v159
    v_mfma_f32_16x16x32_bf16 v[184:187], v[220:223], v[148:151], v[184:187]
    s_waitcnt lgkmcnt(6)
    v_mfma_f32_16x16x32_bf16 v[164:167], v[56:59], v[236:239], v[164:167]
    v_mfma_f32_16x16x32_bf16 v[168:171], v[88:91], v[236:239], v[168:171]
    s_waitcnt lgkmcnt(5)
    v_mfma_f32_16x16x32_bf16 v[164:167], v[52:55], v[240:243], v[164:167]
    ds_read_b128 v[236:239], v3 offset:1760
    v_mfma_f32_16x16x32_bf16 v[168:171], v[84:87], v[240:243], v[168:171]
    s_waitcnt lgkmcnt(5)
    v_mfma_f32_16x16x32_bf16 v[188:191], v[244:247], v[8:11], 0
    ds_read_b128 v[240:243], v3 offset:1824
    v_mfma_f32_16x16x32_bf16 v[192:195], v[244:247], v[12:15], 0
    v_mfma_f32_16x16x32_bf16 v[196:199], v[244:247], v[16:19], 0
    s_waitcnt lgkmcnt(5)
    v_mfma_f32_16x16x32_bf16 v[200:203], v[248:251], v[12:15], 0
    v_mfma_f32_16x16x32_bf16 v[204:207], v[244:247], v[20:23], 0
    v_mfma_f32_16x16x32_bf16 v[208:211], v[248:251], v[24:27], 0
    v_mfma_f32_16x16x32_bf16 v[164:167], v[48:51], v[244:247], v[164:167]
    v_mfma_f32_16x16x32_bf16 v[168:171], v[80:83], v[244:247], v[168:171]
    v_mfma_f32_16x16x32_bf16 v[172:175], v[112:115], v[244:247], v[172:175]
    v_mfma_f32_16x16x32_bf16 v[180:183], v[28:31], v[244:247], v[180:183]
    s_waitcnt lgkmcnt(4)
    v_mfma_f32_16x16x32_bf16 v[168:171], v[76:79], v[224:227], v[168:171]
    ds_read_b128 v[244:247], v3 offset:1888
    v_cvt_pk_bf16_f32 v212, v189, v193
    v_mfma_f32_16x16x32_bf16 v[172:175], v[108:111], v[224:227], v[172:175]
    v_cvt_pk_bf16_f32 v213, v197, v201
    v_cvt_pk_bf16_f32 v214, v188, v192
    s_waitcnt lgkmcnt(4)
    v_mfma_f32_16x16x32_bf16 v[168:171], v[72:75], v[228:231], v[168:171]
    v_cvt_pk_bf16_f32 v215, v196, v200
    v_cvt_pk_bf16_f32 v216, v191, v195
    v_mfma_f32_16x16x32_bf16 v[172:175], v[104:107], v[228:231], v[172:175]
    v_cvt_pk_bf16_f32 v217, v199, v203
    v_cvt_pk_bf16_f32 v218, v190, v194
    s_waitcnt lgkmcnt(3)
    v_mfma_f32_16x16x32_bf16 v[168:171], v[68:71], v[232:235], v[168:171]
    v_cvt_pk_bf16_f32 v219, v198, v202
    ds_read_b128 v[224:227], v3 offset:1952
    v_mfma_f32_16x16x32_bf16 v[172:175], v[100:103], v[232:235], v[172:175]
    v_cvt_pk_bf16_f32 v220, v207, v211
    v_cvt_pk_bf16_f32 v221, v206, v210
    v_mfma_f32_16x16x32_bf16 v[172:175], v[212:215], v[116:119], v[172:175]
    v_cvt_pk_bf16_f32 v222, v205, v209
    v_cvt_pk_bf16_f32 v223, v204, v208
    v_mfma_f32_16x16x32_bf16 v[176:179], v[212:215], v[124:127], v[176:179]
    ds_read_b128 v[228:231], v3 offset:2016
    ds_read_b128 v[248:251], v3 offset:2000
    v_mfma_f32_16x16x32_bf16 v[180:183], v[212:215], v[132:135], v[180:183]
    ds_read_b128 v[232:235], v3 offset:2080
    s_waitcnt lgkmcnt(6)
    v_mfma_f32_16x16x32_bf16 v[168:171], v[64:67], v[236:239], v[168:171]
    v_mfma_f32_16x16x32_bf16 v[172:175], v[96:99], v[236:239], v[172:175]
    v_mfma_f32_16x16x32_bf16 v[172:175], v[216:219], v[120:123], v[172:175]
    ds_read_b128 v[236:239], v3 offset:2144
    v_mfma_f32_16x16x32_bf16 v[176:179], v[216:219], v[128:131], v[176:179]
    v_mfma_f32_16x16x32_bf16 v[180:183], v[216:219], v[136:139], v[180:183]
    s_waitcnt lgkmcnt(6)
    v_mfma_f32_16x16x32_bf16 v[168:171], v[60:63], v[240:243], v[168:171]
    v_cvt_pk_bf16_f32 v164, v164, v165
    v_cvt_pk_bf16_f32 v165, v166, v167
    v_mfma_f32_16x16x32_bf16 v[172:175], v[92:95], v[240:243], v[172:175]
    v_mfma_f32_16x16x32_bf16 v[180:183], v[220:223], v[140:143], v[180:183]
    ds_read_b128 v[240:243], v3 offset:2208
    v_mfma_f32_16x16x32_bf16 v[184:187], v[220:223], v[144:147], v[184:187]
    s_waitcnt lgkmcnt(6)
    v_mfma_f32_16x16x32_bf16 v[168:171], v[56:59], v[244:247], v[168:171]
    v_mfma_f32_16x16x32_bf16 v[172:175], v[88:91], v[244:247], v[172:175]
    s_waitcnt lgkmcnt(5)
    v_mfma_f32_16x16x32_bf16 v[168:171], v[52:55], v[224:227], v[168:171]
    ds_read_b128 v[244:247], v3 offset:2272
    v_mfma_f32_16x16x32_bf16 v[172:175], v[84:87], v[224:227], v[172:175]
    s_waitcnt lgkmcnt(5)
    v_mfma_f32_16x16x32_bf16 v[188:191], v[228:231], v[8:11], 0
    ds_read_b128 v[224:227], v3 offset:2336
    v_mfma_f32_16x16x32_bf16 v[192:195], v[228:231], v[12:15], 0
    v_mfma_f32_16x16x32_bf16 v[196:199], v[228:231], v[16:19], 0
    s_waitcnt lgkmcnt(5)
    v_mfma_f32_16x16x32_bf16 v[200:203], v[248:251], v[12:15], 0
    v_mfma_f32_16x16x32_bf16 v[204:207], v[228:231], v[20:23], 0
    v_mfma_f32_16x16x32_bf16 v[208:211], v[248:251], v[24:27], 0
    v_mfma_f32_16x16x32_bf16 v[168:171], v[48:51], v[228:231], v[168:171]
    v_mfma_f32_16x16x32_bf16 v[172:175], v[80:83], v[228:231], v[172:175]
    v_mfma_f32_16x16x32_bf16 v[176:179], v[112:115], v[228:231], v[176:179]
    v_mfma_f32_16x16x32_bf16 v[184:187], v[28:31], v[228:231], v[184:187]
    s_waitcnt lgkmcnt(4)
    v_mfma_f32_16x16x32_bf16 v[172:175], v[76:79], v[232:235], v[172:175]
    ds_read_b128 v[228:231], v3 offset:2400
    v_cvt_pk_bf16_f32 v212, v189, v193
    v_mfma_f32_16x16x32_bf16 v[176:179], v[108:111], v[232:235], v[176:179]
    v_cvt_pk_bf16_f32 v213, v197, v201
    v_cvt_pk_bf16_f32 v214, v188, v192
    s_waitcnt lgkmcnt(4)
    v_mfma_f32_16x16x32_bf16 v[172:175], v[72:75], v[236:239], v[172:175]
    v_cvt_pk_bf16_f32 v215, v196, v200
    v_cvt_pk_bf16_f32 v216, v191, v195
    v_mfma_f32_16x16x32_bf16 v[176:179], v[104:107], v[236:239], v[176:179]
    v_cvt_pk_bf16_f32 v217, v199, v203
    v_cvt_pk_bf16_f32 v218, v190, v194
    s_waitcnt lgkmcnt(3)
    v_mfma_f32_16x16x32_bf16 v[172:175], v[68:71], v[240:243], v[172:175]
    v_cvt_pk_bf16_f32 v219, v198, v202
    ds_read_b128 v[232:235], v3 offset:2464
    v_mfma_f32_16x16x32_bf16 v[176:179], v[100:103], v[240:243], v[176:179]
    v_cvt_pk_bf16_f32 v220, v207, v211
    v_cvt_pk_bf16_f32 v221, v206, v210
    v_mfma_f32_16x16x32_bf16 v[176:179], v[212:215], v[116:119], v[176:179]
    v_cvt_pk_bf16_f32 v222, v205, v209
    v_cvt_pk_bf16_f32 v223, v204, v208
    v_mfma_f32_16x16x32_bf16 v[180:183], v[212:215], v[124:127], v[180:183]
    ds_read_b128 v[236:239], v3 offset:2528
    ds_read_b128 v[248:251], v3 offset:2512
    v_mfma_f32_16x16x32_bf16 v[184:187], v[212:215], v[132:135], v[184:187]
    ds_read_b128 v[240:243], v3 offset:2592
    s_waitcnt lgkmcnt(6)
    v_mfma_f32_16x16x32_bf16 v[172:175], v[64:67], v[244:247], v[172:175]
    v_mfma_f32_16x16x32_bf16 v[176:179], v[96:99], v[244:247], v[176:179]
    v_mfma_f32_16x16x32_bf16 v[176:179], v[216:219], v[120:123], v[176:179]
    ds_read_b128 v[244:247], v3 offset:2656
    v_mfma_f32_16x16x32_bf16 v[180:183], v[216:219], v[128:131], v[180:183]
    v_mfma_f32_16x16x32_bf16 v[184:187], v[216:219], v[136:139], v[184:187]
    s_waitcnt lgkmcnt(6)
    v_mfma_f32_16x16x32_bf16 v[172:175], v[60:63], v[224:227], v[172:175]
    v_cvt_pk_bf16_f32 v166, v168, v169
    v_cvt_pk_bf16_f32 v167, v170, v171
    v_mfma_f32_16x16x32_bf16 v[176:179], v[92:95], v[224:227], v[176:179]
    v_mfma_f32_16x16x32_bf16 v[184:187], v[220:223], v[140:143], v[184:187]
    ds_read_b128 v[224:227], v3 offset:2720
    v_permlane32_swap_b32 v164, v166
    s_waitcnt lgkmcnt(6)
    v_mfma_f32_16x16x32_bf16 v[172:175], v[56:59], v[228:231], v[172:175]
    v_permlane32_swap_b32 v165, v167
    v_mfma_f32_16x16x32_bf16 v[176:179], v[88:91], v[228:231], v[176:179]
    s_waitcnt lgkmcnt(5)
    v_mfma_f32_16x16x32_bf16 v[172:175], v[52:55], v[232:235], v[172:175]
    ds_read_b128 v[228:231], v3 offset:2784
    v_mfma_f32_16x16x32_bf16 v[176:179], v[84:87], v[232:235], v[176:179]
    s_waitcnt lgkmcnt(5)
    v_mfma_f32_16x16x32_bf16 v[188:191], v[236:239], v[8:11], 0
    ds_read_b128 v[232:235], v3 offset:2848
    v_mfma_f32_16x16x32_bf16 v[192:195], v[236:239], v[12:15], 0
    v_mfma_f32_16x16x32_bf16 v[196:199], v[236:239], v[16:19], 0
    s_waitcnt lgkmcnt(5)
    v_mfma_f32_16x16x32_bf16 v[200:203], v[248:251], v[12:15], 0
    v_mfma_f32_16x16x32_bf16 v[172:175], v[48:51], v[236:239], v[172:175]
    v_mfma_f32_16x16x32_bf16 v[176:179], v[80:83], v[236:239], v[176:179]
    v_mfma_f32_16x16x32_bf16 v[180:183], v[112:115], v[236:239], v[180:183]
    s_waitcnt lgkmcnt(4)
    v_mfma_f32_16x16x32_bf16 v[176:179], v[76:79], v[240:243], v[176:179]
    ds_read_b128 v[236:239], v3 offset:2912
    v_mfma_f32_16x16x32_bf16 v[180:183], v[108:111], v[240:243], v[180:183]
    s_waitcnt lgkmcnt(4)
    v_mfma_f32_16x16x32_bf16 v[176:179], v[72:75], v[244:247], v[176:179]
    ds_read_b128 v[240:243], v3 offset:2976
    v_cvt_pk_bf16_f32 v212, v189, v193
    v_mfma_f32_16x16x32_bf16 v[180:183], v[104:107], v[244:247], v[180:183]
    v_cvt_pk_bf16_f32 v213, v197, v201
    v_cvt_pk_bf16_f32 v214, v188, v192
    s_waitcnt lgkmcnt(4)
    v_mfma_f32_16x16x32_bf16 v[176:179], v[68:71], v[224:227], v[176:179]
    v_cvt_pk_bf16_f32 v215, v196, v200
    v_cvt_pk_bf16_f32 v216, v191, v195
    v_mfma_f32_16x16x32_bf16 v[180:183], v[100:103], v[224:227], v[180:183]
    v_cvt_pk_bf16_f32 v217, v199, v203
    v_cvt_pk_bf16_f32 v218, v190, v194
    v_mfma_f32_16x16x32_bf16 v[180:183], v[212:215], v[116:119], v[180:183]
    v_cvt_pk_bf16_f32 v219, v198, v202
    ds_read_b128 v[244:247], v3 offset:3040
    v_mfma_f32_16x16x32_bf16 v[184:187], v[212:215], v[124:127], v[184:187]
    ds_read_b128 v[248:251], v3 offset:3024
    ds_read_b128 v[224:227], v3 offset:3104
    s_waitcnt lgkmcnt(6)
    v_mfma_f32_16x16x32_bf16 v[176:179], v[64:67], v[228:231], v[176:179]
    v_mfma_f32_16x16x32_bf16 v[180:183], v[96:99], v[228:231], v[180:183]
    v_mfma_f32_16x16x32_bf16 v[180:183], v[216:219], v[120:123], v[180:183]
    ds_read_b128 v[228:231], v3 offset:3168
    v_mfma_f32_16x16x32_bf16 v[184:187], v[216:219], v[128:131], v[184:187]
    s_waitcnt lgkmcnt(6)
    v_mfma_f32_16x16x32_bf16 v[176:179], v[60:63], v[232:235], v[176:179]
    v_cvt_pk_bf16_f32 v172, v172, v173
    v_cvt_pk_bf16_f32 v173, v174, v175
    v_mfma_f32_16x16x32_bf16 v[180:183], v[92:95], v[232:235], v[180:183]
    s_waitcnt lgkmcnt(5)
    v_mfma_f32_16x16x32_bf16 v[176:179], v[56:59], v[236:239], v[176:179]
    ds_read_b128 v[232:235], v3 offset:3232
    v_mfma_f32_16x16x32_bf16 v[180:183], v[88:91], v[236:239], v[180:183]
    s_waitcnt lgkmcnt(5)
    v_mfma_f32_16x16x32_bf16 v[176:179], v[52:55], v[240:243], v[176:179]
    ds_read_b128 v[236:239], v3 offset:3296
    v_mfma_f32_16x16x32_bf16 v[180:183], v[84:87], v[240:243], v[180:183]
    s_waitcnt lgkmcnt(5)
    v_mfma_f32_16x16x32_bf16 v[188:191], v[244:247], v[8:11], 0
    ds_read_b128 v[240:243], v3 offset:3360
    v_mfma_f32_16x16x32_bf16 v[192:195], v[244:247], v[12:15], 0
    v_mfma_f32_16x16x32_bf16 v[196:199], v[244:247], v[16:19], 0
    s_waitcnt lgkmcnt(5)
    v_mfma_f32_16x16x32_bf16 v[200:203], v[248:251], v[12:15], 0
    v_mfma_f32_16x16x32_bf16 v[176:179], v[48:51], v[244:247], v[176:179]
    v_mfma_f32_16x16x32_bf16 v[180:183], v[80:83], v[244:247], v[180:183]
    v_mfma_f32_16x16x32_bf16 v[184:187], v[112:115], v[244:247], v[184:187]
    s_waitcnt lgkmcnt(4)
    v_mfma_f32_16x16x32_bf16 v[180:183], v[76:79], v[224:227], v[180:183]
    ds_read_b128 v[244:247], v3 offset:3424
    v_mfma_f32_16x16x32_bf16 v[184:187], v[108:111], v[224:227], v[184:187]
    s_waitcnt lgkmcnt(4)
    v_mfma_f32_16x16x32_bf16 v[180:183], v[72:75], v[228:231], v[180:183]
    ds_read_b128 v[224:227], v3 offset:3488
    v_cvt_pk_bf16_f32 v212, v189, v193
    v_mfma_f32_16x16x32_bf16 v[184:187], v[104:107], v[228:231], v[184:187]
    v_cvt_pk_bf16_f32 v213, v197, v201
    v_cvt_pk_bf16_f32 v214, v188, v192
    s_waitcnt lgkmcnt(4)
    v_mfma_f32_16x16x32_bf16 v[180:183], v[68:71], v[232:235], v[180:183]
    v_cvt_pk_bf16_f32 v215, v196, v200
    v_cvt_pk_bf16_f32 v216, v191, v195
    v_mfma_f32_16x16x32_bf16 v[184:187], v[100:103], v[232:235], v[184:187]
    v_cvt_pk_bf16_f32 v217, v199, v203
    v_cvt_pk_bf16_f32 v218, v190, v194
    v_mfma_f32_16x16x32_bf16 v[184:187], v[212:215], v[116:119], v[184:187]
    v_cvt_pk_bf16_f32 v219, v198, v202
    ds_read_b128 v[228:231], v3 offset:3552
    s_waitcnt lgkmcnt(4)
    v_mfma_f32_16x16x32_bf16 v[180:183], v[64:67], v[236:239], v[180:183]
    ds_read_b128 v[232:235], v3 offset:3616
    v_mfma_f32_16x16x32_bf16 v[184:187], v[96:99], v[236:239], v[184:187]
    v_mfma_f32_16x16x32_bf16 v[184:187], v[216:219], v[120:123], v[184:187]
    ds_read_b128 v[236:239], v3 offset:3680
    s_waitcnt lgkmcnt(5)
    v_mfma_f32_16x16x32_bf16 v[180:183], v[60:63], v[240:243], v[180:183]
    v_cvt_pk_bf16_f32 v174, v176, v177
    v_cvt_pk_bf16_f32 v175, v178, v179
    v_mfma_f32_16x16x32_bf16 v[184:187], v[92:95], v[240:243], v[184:187]
    s_waitcnt lgkmcnt(4)
    v_mfma_f32_16x16x32_bf16 v[180:183], v[56:59], v[244:247], v[180:183]
    ds_read_b128 v[240:243], v3 offset:3744
    v_permlane32_swap_b32 v172, v174
    v_mfma_f32_16x16x32_bf16 v[184:187], v[88:91], v[244:247], v[184:187]
    v_permlane32_swap_b32 v173, v175
    s_waitcnt lgkmcnt(4)
    v_mfma_f32_16x16x32_bf16 v[180:183], v[52:55], v[224:227], v[180:183]
    ds_read_b128 v[244:247], v3 offset:3808
    v_mfma_f32_16x16x32_bf16 v[184:187], v[84:87], v[224:227], v[184:187]
    s_waitcnt lgkmcnt(4)
    v_mfma_f32_16x16x32_bf16 v[180:183], v[48:51], v[228:231], v[180:183]
    ds_read_b128 v[224:227], v3 offset:3872
    buffer_store_dwordx4 v[156:159], v37, s[52:55], s71 offen sc1
    s_add_u32 s71, s71, 82944
    v_mfma_f32_16x16x32_bf16 v[184:187], v[80:83], v[228:231], v[184:187]
    buffer_store_dwordx4 v[164:167], v37, s[52:55], s71 offen sc1
    s_add_u32 s71, s71, 82944
    buffer_store_dwordx4 v[172:175], v37, s[52:55], s71 offen sc1
    s_add_u32 s71, s71, 82944
    s_waitcnt lgkmcnt(4)
    v_mfma_f32_16x16x32_bf16 v[184:187], v[76:79], v[232:235], v[184:187]
    ds_read_b128 v[228:231], v3 offset:3936
    s_waitcnt lgkmcnt(4)
    v_mfma_f32_16x16x32_bf16 v[184:187], v[72:75], v[236:239], v[184:187]
    ds_read_b128 v[232:235], v3 offset:4000
    s_waitcnt lgkmcnt(4)
    v_mfma_f32_16x16x32_bf16 v[184:187], v[68:71], v[240:243], v[184:187]
    ds_read_b128 v[236:239], v3 offset:4064
    s_waitcnt lgkmcnt(4)
    v_mfma_f32_16x16x32_bf16 v[184:187], v[64:67], v[244:247], v[184:187]
    s_waitcnt lgkmcnt(3)
    v_mfma_f32_16x16x32_bf16 v[184:187], v[60:63], v[224:227], v[184:187]
    v_cvt_pk_bf16_f32 v180, v180, v181
    v_cvt_pk_bf16_f32 v181, v182, v183
    s_waitcnt lgkmcnt(2)
    v_mfma_f32_16x16x32_bf16 v[184:187], v[56:59], v[228:231], v[184:187]
    s_waitcnt lgkmcnt(1)
    v_mfma_f32_16x16x32_bf16 v[184:187], v[52:55], v[232:235], v[184:187]
    s_waitcnt lgkmcnt(0)
    v_mfma_f32_16x16x32_bf16 v[184:187], v[48:51], v[236:239], v[184:187]
    s_nop 7
    v_cvt_pk_bf16_f32 v182, v184, v185
    v_cvt_pk_bf16_f32 v183, v186, v187
    s_nop 0
    v_permlane32_swap_b32 v180, v182
    v_permlane32_swap_b32 v181, v183
    buffer_store_dwordx4 v[180:183], v37, s[52:55], s71 offen sc1
    s_add_u32 s71, s71, 82944
    v_mov_b32 v41, 1
    s_lshl_b32 s44, s42, 7
    s_load_dword s99, s[38:39], s44
    s_waitcnt lgkmcnt(0)
    s_mul_i32 s43, s99, 1664525
    s_add_u32 s43, s43, 1013904223
    s_mov_b32 s96, s43
    s_mov_b32 s97, s43
    s_lshl_b32 s45, s42, 17
    s_lshl_b32 s46, s41, 2
    s_add_u32 s45, s45, s46
    s_add_u32 s45, s45, 15204352
    s_and_b32 s46, s41, 1
    s_sub_u32 s46, 2, s46
    v_lshlrev_b32 v43, 12, v1
    s_setprio 3
    s_waitcnt vmcnt(0)
    s_mov_b64 exec, 1
    ds_add_rtn_u32 v42, v39, v41 offset:28
    s_mov_b64 exec, -1
    s_waitcnt lgkmcnt(0)
    v_readfirstlane_b32 s44, v42
    s_nop 0
    s_cmp_lg_u32 s44, s46
    s_cbranch_scc1 L_cv_nosig
    v_mov_b32 v41, s43
    s_mov_b32 exec_hi, 0
    buffer_store_dword v41, v43, s[52:55], s45 offen offset:1024 sc1
    s_mov_b64 exec, -1
L_cv_nosig:
    s_endpgm
L_help_body:
    s_mov_b64 s[76:77], s[34:35]
    s_mov_b32 s52, s38
    s_mov_b32 s53, s39
    s_mov_b32 s54, 0x1000000
    s_mov_b32 s55, 0x20000
    s_mul_i32 s45, s42, 160
    s_mov_b32 s56, s32
    s_mov_b32 s57, s33
    s_mov_b32 s58, 0x500
    s_mov_b32 s59, 0x20000
    s_mov_b32 s64, s30
    s_mov_b32 s65, s31
    s_mov_b32 s66, 0x500
    s_mov_b32 s67, 0x20000
    s_mul_i32 s44, s98, 5
    s_lshr_b32 s44, s44, 2
    s_lshl_b32 s44, s44, 7
    v_add_u32 v12, s44, v7
    v_subrev_u32 v14, 1280, v12
    v_min_u32 v12, v12, v14
    v_add_u32 v13, s44, v7
    v_add_u32 v13, 1024, v13
    v_subrev_u32 v14, 1280, v13
    v_min_u32 v13, v13, v14
    s_mov_b32 m0, 159744
    s_nop 0
    buffer_load_dwordx4 v12, s[56:59], 0 offen lds
    s_mov_b32 m0, 160768
    s_mov_b64 exec, 0xffff
    buffer_load_dwordx4 v13, s[56:59], 0 offen lds
    s_mov_b32 m0, 161408
    s_mov_b64 exec, 0x3ff
    buffer_load_dwordx4 v7, s[64:67], s45 offen lds
    s_mov_b64 exec, -1
    s_lshl_b32 s71, s42, 17
    s_add_u32 s71, s71, 15204352
    s_lshl_b32 s44, s41, 12
    s_add_u32 s44, s44, s71
    s_add_u32 s74, s38, s44
    s_addc_u32 s75, s39, 0
    s_lshl_b32 s44, s41, 2
    s_add_u32 s71, s71, s44
    s_lshl_b32 s72, s98, 17
    s_add_u32 s72, s72, s44
    s_add_u32 s72, s72, 15204352
    v_lshlrev_b32 v100, 12, v1
    v_lshrrev_b32 v9, 4, v1
    v_bfe_u32 v10, v1, 2, 2
    v_lshl_add_u32 v12, v9, 3, v10
    v_lshlrev_b32 v12, 7, v12
    v_and_b32 v14, 1, v1
    v_lshl_add_u32 v12, v14, 3, v12
    v_xor_b32 v14, v1, v10
    v_and_b32 v14, 2, v14
    v_lshl_add_u32 v12, v14, 3, v12
    v_and_b32 v14, 16, v1
    v_lshl_add_u32 v12, v14, 2, v12
    s_and_b32 s45, s98, 3
    s_add_u32 s44, s45, 0
    s_mul_i32 s44, s44, 2080
    s_and_b32 s44, s44, 8288
    v_xor_b32 v104, s44, v12
    v_xor_b32 v105, 32, v104
    s_add_u32 s44, s45, 1
    s_mul_i32 s44, s44, 2080
    s_and_b32 s44, s44, 8288
    v_xor_b32 v106, s44, v12
    v_xor_b32 v107, 32, v106
    s_add_u32 s44, s45, 2
    s_mul_i32 s44, s44, 2080
    s_and_b32 s44, s44, 8288
    v_xor_b32 v108, s44, v12
    v_xor_b32 v109, 32, v108
    s_add_u32 s44, s45, 3
    s_mul_i32 s44, s44, 2080
    s_and_b32 s44, s44, 8288
    v_xor_b32 v110, s44, v12
    v_xor_b32 v111, 32, v110
    s_add_u32 s44, s45, 4
    s_mul_i32 s44, s44, 2080
    s_and_b32 s44, s44, 8288
    v_xor_b32 v112, s44, v12
    v_xor_b32 v113, 32, v112
    v_and_b32 v10, 7, v1
    v_xor_b32 v96, v9, v10
    v_lshlrev_b32 v96, 4, v96
    v_and_b32 v14, 15, v1
    v_lshl_add_u32 v96, v14, 7, v96
    v_xor_b32 v97, 64, v96
    v_lshrrev_b32 v14, 3, v1
    v_xor_b32 v98, v14, v10
    v_lshlrev_b32 v98, 4, v98
    v_lshl_add_u32 v98, v14, 7, v98
    v_mul_u32_u24 v99, 4224, v14
    v_lshl_add_u32 v99, v10, 4, v99
    s_mul_i32 s70, s98, 337920
    s_lshl_b32 s44, s41, 7
    s_add_u32 s70, s70, s44
    s_add_u32 s70, s70, 524288
    v_min_u32 v124, 30, v1
    v_lshlrev_b32 v125, 2, v1
    v_add_u32 v125, 161600, v125
    s_mov_b32 s44, 0x1c000000
    v_bfe_u32 v116, s44, v124, 2
    v_mul_u32_u24 v116, 0x8001, v116
    v_and_b32 v116, 0x10001, v116
    v_mul_u32_u24 v116, 0x3f80, v116
    ds_write_b32 v125, v116 offset:0
    s_mov_b32 s44, 0x3e00000
    v_bfe_u32 v117, s44, v124, 2
    v_mul_u32_u24 v117, 0x8001, v117
    v_and_b32 v117, 0x10001, v117
    v_mul_u32_u24 v117, 0x3f80, v117
    ds_write_b32 v125, v117 offset:256
    s_mov_b32 s44, 0x1c0000
    v_bfe_u32 v118, s44, v124, 2
    v_mul_u32_u24 v118, 0x8001, v118
    v_and_b32 v118, 0x10001, v118
    v_mul_u32_u24 v118, 0x3f80, v118
    ds_write_b32 v125, v118 offset:512
    s_mov_b32 s44, 0x7f00000
    v_bfe_u32 v119, s44, v124, 2
    v_mul_u32_u24 v119, 0x8001, v119
    v_and_b32 v119, 0x10001, v119
    v_mul_u32_u24 v119, 0x3f80, v119
    ds_write_b32 v125, v119 offset:768
    s_mov_b32 s44, 0xff80000
    v_bfe_u32 v120, s44, v124, 2
    v_mul_u32_u24 v120, 0x8001, v120
    v_and_b32 v120, 0x10001, v120
    v_mul_u32_u24 v120, 0x3f80, v120
    ds_write_b32 v125, v120 offset:1024
    s_mov_b32 s44, 0x18000000
    v_bfe_u32 v121, s44, v124, 2
    v_mul_u32_u24 v121, 0x8001, v121
    v_and_b32 v121, 0x10001, v121
    v_mul_u32_u24 v121, 0xffff, v121
    ds_write_b32 v125, v121 offset:1280
    s_waitcnt vmcnt(3)
    s_mov_b64 exec, 1
    ds_add_u32 v11, v15 offset:0
    s_mov_b64 exec, -1
    s_waitcnt lgkmcnt(0)
    s_mov_b32 s48, 0
L_spin_17:
    ds_read_b32 v10, v11 offset:0
    s_add_u32 s48, s48, 1
    s_waitcnt lgkmcnt(0)
    v_readfirstlane_b32 s44, v10
    s_nop 0
    s_cmp_ge_u32 s44, 5
    s_cbranch_scc1 L_spun_18
    s_cmp_lt_u32 s48, 400000
    s_cbranch_scc1 L_spin_17
L_spun_18:
    ds_read_b64_tr_b16 v[56:57], v104 offset:28672
    ds_read_b64_tr_b16 v[58:59], v105 offset:29184
    ds_read_b64_tr_b16 v[60:61], v104 offset:32768
    ds_read_b64_tr_b16 v[62:63], v105 offset:33280
    ds_read_b64_tr_b16 v[64:65], v106 offset:28672
    ds_read_b64_tr_b16 v[66:67], v107 offset:29184
    ds_read_b64_tr_b16 v[68:69], v106 offset:32768
    ds_read_b64_tr_b16 v[70:71], v107 offset:33280
    ds_read_b64_tr_b16 v[72:73], v108 offset:28672
    ds_read_b64_tr_b16 v[74:75], v109 offset:29184
    ds_read_b64_tr_b16 v[76:77], v108 offset:32768
    ds_read_b64_tr_b16 v[78:79], v109 offset:33280
    ds_read_b64_tr_b16 v[80:81], v110 offset:28672
    ds_read_b64_tr_b16 v[82:83], v111 offset:29184
    ds_read_b64_tr_b16 v[84:85], v110 offset:32768
    ds_read_b64_tr_b16 v[86:87], v111 offset:33280
    ds_read_b64_tr_b16 v[88:89], v112 offset:28672
    ds_read_b64_tr_b16 v[90:91], v113 offset:29184
    ds_read_b64_tr_b16 v[92:93], v112 offset:32768
    ds_read_b64_tr_b16 v[94:95], v113 offset:33280
    s_waitcnt lgkmcnt(15)
    ds_write_b128 v96, v[56:59] offset:24576
    ds_write_b128 v97, v[60:63] offset:24576
    ds_read_b128 v[56:59], v98 offset:24576
    ds_read_b128 v[60:63], v98 offset:25600
    s_waitcnt lgkmcnt(15)
    ds_write_b128 v96, v[64:67] offset:24576
    ds_write_b128 v97, v[68:71] offset:24576
    ds_read_b128 v[64:67], v98 offset:24576
    ds_read_b128 v[68:71], v98 offset:25600
    s_waitcnt lgkmcnt(5)
    buffer_store_dwordx4 v[56:59], v99, s[52:55], s70 offen sc1
    s_add_u32 s70, s70, 33792
    s_waitcnt lgkmcnt(4)
    buffer_store_dwordx4 v[60:63], v99, s[52:55], s70 offen sc1
    s_add_u32 s70, s70, 33792
    ds_write_b128 v96, v[72:75] offset:24576
    ds_write_b128 v97, v[76:79] offset:24576
    ds_read_b128 v[72:75], v98 offset:24576
    ds_read_b128 v[76:79], v98 offset:25600
    s_waitcnt lgkmcnt(5)
    buffer_store_dwordx4 v[64:67], v99, s[52:55], s70 offen sc1
    s_add_u32 s70, s70, 33792
    s_waitcnt lgkmcnt(4)
    buffer_store_dwordx4 v[68:71], v99, s[52:55], s70 offen sc1
    s_add_u32 s70, s70, 33792
    ds_write_b128 v96, v[80:83] offset:24576
    ds_write_b128 v97, v[84:87] offset:24576
    ds_read_b128 v[80:83], v98 offset:24576
    ds_read_b128 v[84:87], v98 offset:25600
    s_waitcnt lgkmcnt(5)
    buffer_store_dwordx4 v[72:75], v99, s[52:55], s70 offen sc1
    s_add_u32 s70, s70, 33792
    s_waitcnt lgkmcnt(4)
    buffer_store_dwordx4 v[76:79], v99, s[52:55], s70 offen sc1
    s_add_u32 s70, s70, 33792
    ds_write_b128 v96, v[88:91] offset:24576
    ds_write_b128 v97, v[92:95] offset:24576
    ds_read_b128 v[88:91], v98 offset:24576
    ds_read_b128 v[92:95], v98 offset:25600
    s_waitcnt lgkmcnt(5)
    buffer_store_dwordx4 v[80:83], v99, s[52:55], s70 offen sc1
    s_add_u32 s70, s70, 33792
    s_waitcnt lgkmcnt(4)
    buffer_store_dwordx4 v[84:87], v99, s[52:55], s70 offen sc1
    s_add_u32 s70, s70, 33792
    s_waitcnt lgkmcnt(1)
    buffer_store_dwordx4 v[88:91], v99, s[52:55], s70 offen sc1
    s_add_u32 s70, s70, 33792
    s_waitcnt lgkmcnt(0)
    buffer_store_dwordx4 v[92:95], v99, s[52:55], s70 offen sc1
    s_add_u32 s70, s70, 33792
    s_waitcnt lgkmcnt(0)
    s_lshl_b32 s44, s42, 7
    s_load_dword s99, s[38:39], s44
    s_lshl_b32 s44, s98, 7
    s_load_dword s100, s[38:39], s44
    s_load_dword s16, s[74:75], 0 glc
    s_load_dword s17, s[74:75], 64 glc
    s_load_dword s18, s[74:75], 1024 glc
    s_load_dword s19, s[74:75], 1088 glc
    s_load_dword s20, s[74:75], 2048 glc
    s_load_dword s21, s[74:75], 2176 glc
    s_load_dword s22, s[74:75], 2304 glc
    s_load_dword s23, s[74:75], 2432 glc
    s_load_dword s24, s[74:75], 2560 glc
    s_load_dword s25, s[74:75], 2688 glc
    s_load_dword s26, s[74:75], 2816 glc
    s_load_dword s27, s[74:75], 2944 glc
    s_lshr_b32 s70, s41, 1
    s_mul_i32 s70, s70, 5
    s_and_b32 s69, s41, 1
    s_mul_i32 s44, s69, 3
    s_add_u32 s70, s70, s44
    s_mul_i32 s44, s42, 80
    s_add_u32 s70, s70, s44
    s_mul_i32 s70, s70, 4224
    s_add_u32 s70, s70, 524288
    s_waitcnt vmcnt(0)
    s_waitcnt lgkmcnt(0)
    s_mov_b32 s48, 0
L_spin_19:
    ds_read_b32 v10, v11 offset:12
    s_add_u32 s48, s48, 1
    s_waitcnt lgkmcnt(0)
    v_readfirstlane_b32 s44, v10
    s_nop 0
    s_cmp_ge_u32 s44, s69
    s_cbranch_scc1 L_spun_20
    s_cmp_lt_u32 s48, 400000
    s_cbranch_scc1 L_spin_19
L_spun_20:
    s_mul_i32 s43, s100, 1664525
    s_add_u32 s43, s43, 1013904223
    s_mov_b32 s96, s43
    s_mov_b32 s97, s43
    v_mov_b32 v9, s43
    s_mov_b32 exec_hi, 0
    buffer_store_dword v9, v100, s[52:55], s72 offen offset:0 sc1
    s_mov_b64 exec, -1
    s_mul_i32 s43, s99, 1664525
    s_add_u32 s43, s43, 1013904223
    s_mov_b32 s96, s43
    s_mov_b32 s97, s43
    v_lshlrev_b32 v14, 3, v1
    v_mov_b32 v102, 0
    v_mov_b32 v103, 0
    ds_write_b64 v14, v[102:103] offset:13824
    ds_write_b64 v14, v[102:103] offset:18432
    ds_write_b64 v14, v[102:103] offset:23040
    s_mov_b32 s48, 0
    s_waitcnt lgkmcnt(0)
L_poll_21:
    s_load_dwordx16 s[4:19], s[74:75], 0 glc
    s_load_dwordx16 s[20:35], s[74:75], 64 glc
    s_add_u32 s48, s48, 1
    s_cmp_ge_u32 s48, 40000
    s_waitcnt lgkmcnt(0)
    s_cbranch_scc1 L_polled_22
    s_cmp_lg_u64 s[4:5], s[96:97]
    s_cbranch_scc1 L_poll_21
    s_cmp_lg_u64 s[6:7], s[96:97]
    s_cbranch_scc1 L_poll_21
    s_cmp_lg_u64 s[8:9], s[96:97]
    s_cbranch_scc1 L_poll_21
    s_cmp_lg_u64 s[10:11], s[96:97]
    s_cbranch_scc1 L_poll_21
    s_cmp_lg_u64 s[12:13], s[96:97]
    s_cbranch_scc1 L_poll_21
    s_cmp_lg_u64 s[14:15], s[96:97]
    s_cbranch_scc1 L_poll_21
    s_cmp_lg_u64 s[16:17], s[96:97]
    s_cbranch_scc1 L_poll_21
    s_cmp_lg_u64 s[18:19], s[96:97]
    s_cbranch_scc1 L_poll_21
    s_cmp_lg_u64 s[20:21], s[96:97]
    s_cbranch_scc1 L_poll_21
    s_cmp_lg_u64 s[22:23], s[96:97]
    s_cbranch_scc1 L_poll_21
    s_cmp_lg_u64 s[24:25], s[96:97]
    s_cbranch_scc1 L_poll_21
    s_cmp_lg_u64 s[26:27], s[96:97]
    s_cbranch_scc1 L_poll_21
    s_cmp_lg_u64 s[28:29], s[96:97]
    s_cbranch_scc1 L_poll_21
    s_cmp_lg_u64 s[30:31], s[96:97]
    s_cbranch_scc1 L_poll_21
    s_cmp_lg_u64 s[32:33], s[96:97]
    s_cbranch_scc1 L_poll_21
    s_cmp_lg_u64 s[34:35], s[96:97]
    s_cbranch_scc1 L_poll_21
L_polled_22:
    ds_write_b32 v11, v15 offset:16
    s_setprio 0
    s_waitcnt lgkmcnt(0)
    s_mov_b32 s48, 0
L_spin_23:
    ds_read_b32 v10, v11 offset:8
    s_add_u32 s48, s48, 1
    s_waitcnt lgkmcnt(0)
    v_readfirstlane_b32 s44, v10
    s_nop 0
    s_cmp_ge_u32 s44, 8
    s_cbranch_scc1 L_spun_24
    s_cmp_lt_u32 s48, 400000
    s_cbranch_scc1 L_spin_23
L_spun_24:
    s_setprio 3
    s_mov_b32 m0, 14336
    s_nop 0
    buffer_load_dwordx4 v7, s[52:55], s70 offen offset:0 sc1 lds
    buffer_load_dwordx4 v7, s[52:55], s70 offen offset:1024 sc1 lds
    buffer_load_dwordx4 v7, s[52:55], s70 offen offset:2048 sc1 lds
    buffer_load_dwordx4 v7, s[52:55], s70 offen offset:3072 sc1 lds
    s_add_u32 s70, s70, 4224
    s_mov_b32 m0, 18944
    s_nop 0
    buffer_load_dwordx4 v7, s[52:55], s70 offen offset:0 sc1 lds
    buffer_load_dwordx4 v7, s[52:55], s70 offen offset:1024 sc1 lds
    buffer_load_dwordx4 v7, s[52:55], s70 offen offset:2048 sc1 lds
    buffer_load_dwordx4 v7, s[52:55], s70 offen offset:3072 sc1 lds
    s_add_u32 s70, s70, 4224
    s_cmp_eq_u32 s69, 1
    s_cbranch_scc1 L_h_nou2
    s_mov_b32 m0, 23552
    s_nop 0
    buffer_load_dwordx4 v7, s[52:55], s70 offen offset:0 sc1 lds
    buffer_load_dwordx4 v7, s[52:55], s70 offen offset:1024 sc1 lds
    buffer_load_dwordx4 v7, s[52:55], s70 offen offset:2048 sc1 lds
    buffer_load_dwordx4 v7, s[52:55], s70 offen offset:3072 sc1 lds
    s_add_u32 s70, s70, 4224
L_h_nou2:
    s_waitcnt vmcnt(0) lgkmcnt(0)
    ds_write_b32 v11, v15 offset:20
    s_or_b32 s44, s42, 1
    s_mul_i32 s44, s44, 160
    s_sub_u32 s44, s44, 32
    s_and_b32 s45, s42, 1
    s_lshl_b32 s46, s41, 1
    s_add_u32 s45, s45, s46
    s_mul_i32 s45, s45, 40960
    s_add_u32 s44, s44, s45
    s_add_u32 s76, s76, s44
    s_addc_u32 s77, s77, 0
    s_load_dword s4, s[76:77], 0 glc
    s_load_dword s5, s[76:77], 1280 glc
    s_load_dword s6, s[76:77], 2560 glc
    s_load_dword s7, s[76:77], 3840 glc
    s_load_dword s8, s[76:77], 5120 glc
    s_load_dword s9, s[76:77], 6400 glc
    s_load_dword s10, s[76:77], 7680 glc
    s_load_dword s11, s[76:77], 8960 glc
    s_load_dword s12, s[76:77], 10240 glc
    s_load_dword s13, s[76:77], 11520 glc
    s_load_dword s14, s[76:77], 12800 glc
    s_load_dword s15, s[76:77], 14080 glc
    s_load_dword s16, s[76:77], 15360 glc
    s_load_dword s17, s[76:77], 16640 glc
    s_load_dword s18, s[76:77], 17920 glc
    s_load_dword s19, s[76:77], 19200 glc
    s_load_dword s20, s[76:77], 20480 glc
    s_load_dword s21, s[76:77], 21760 glc
    s_load_dword s22, s[76:77], 23040 glc
    s_load_dword s23, s[76:77], 24320 glc
    s_load_dword s24, s[76:77], 25600 glc
    s_load_dword s25, s[76:77], 26880 glc
    s_load_dword s26, s[76:77], 28160 glc
    s_load_dword s27, s[76:77], 29440 glc
    s_load_dword s28, s[76:77], 30720 glc
    s_load_dword s29, s[76:77], 32000 glc
    s_load_dword s30, s[76:77], 33280 glc
    s_load_dword s31, s[76:77], 34560 glc
    s_load_dword s32, s[76:77], 35840 glc
    s_load_dword s33, s[76:77], 37120 glc
    s_load_dword s34, s[76:77], 38400 glc
    s_load_dword s35, s[76:77], 39680 glc
    s_lshl_b32 s70, s42, 5
    s_add_u32 s70, s70, s41
    s_mul_i32 s70, s70, 10368
    s_add_u32 s70, s70, 3670016
    s_sub_u32 s69, 3, s69
    v_and_b32 v12, 48, v1
    v_xor_b32 v12, v12, v7
    s_setprio 0
    s_waitcnt lgkmcnt(0)
    s_mov_b32 s48, 0
L_spin_25:
    ds_read_b32 v10, v11 offset:28
    s_add_u32 s48, s48, 1
    s_waitcnt lgkmcnt(0)
    v_readfirstlane_b32 s44, v10
    s_nop 0
    s_cmp_ge_u32 s44, s69
    s_cbranch_scc1 L_spun_26
    s_cmp_lt_u32 s48, 400000
    s_cbranch_scc1 L_spin_25
L_spun_26:
    s_setprio 3
    s_mov_b32 s48, 0
    s_waitcnt lgkmcnt(0)
L_poll_27:
    s_load_dwordx16 s[4:19], s[74:75], 1024 glc
    s_load_dwordx16 s[20:35], s[74:75], 1088 glc
    s_add_u32 s48, s48, 1
    s_cmp_ge_u32 s48, 40000
    s_waitcnt lgkmcnt(0)
    s_cbranch_scc1 L_polled_28
    s_cmp_lg_u64 s[4:5], s[96:97]
    s_cbranch_scc1 L_poll_27
    s_cmp_lg_u64 s[6:7], s[96:97]
    s_cbranch_scc1 L_poll_27
    s_cmp_lg_u64 s[8:9], s[96:97]
    s_cbranch_scc1 L_poll_27
    s_cmp_lg_u64 s[10:11], s[96:97]
    s_cbranch_scc1 L_poll_27
    s_cmp_lg_u64 s[12:13], s[96:97]
    s_cbranch_scc1 L_poll_27
    s_cmp_lg_u64 s[14:15], s[96:97]
    s_cbranch_scc1 L_poll_27
    s_cmp_lg_u64 s[16:17], s[96:97]
    s_cbranch_scc1 L_poll_27
    s_cmp_lg_u64 s[18:19], s[96:97]
    s_cbranch_scc1 L_poll_27
    s_cmp_lg_u64 s[20:21], s[96:97]
    s_cbranch_scc1 L_poll_27
    s_cmp_lg_u64 s[22:23], s[96:97]
    s_cbranch_scc1 L_poll_27
    s_cmp_lg_u64 s[24:25], s[96:97]
    s_cbranch_scc1 L_poll_27
    s_cmp_lg_u64 s[26:27], s[96:97]
    s_cbranch_scc1 L_poll_27
    s_cmp_lg_u64 s[28:29], s[96:97]
    s_cbranch_scc1 L_poll_27
    s_cmp_lg_u64 s[30:31], s[96:97]
    s_cbranch_scc1 L_poll_27
    s_cmp_lg_u64 s[32:33], s[96:97]
    s_cbranch_scc1 L_poll_27
    s_cmp_lg_u64 s[34:35], s[96:97]
    s_cbranch_scc1 L_poll_27
L_polled_28:
    s_mov_b32 m0, 13824
    s_nop 0
    buffer_load_dwordx4 v12, s[52:55], s70 offen offset:0 sc1 lds
    buffer_load_dwordx4 v12, s[52:55], s70 offen offset:1024 sc1 lds
    buffer_load_dwordx4 v12, s[52:55], s70 offen offset:2048 sc1 lds
    buffer_load_dwordx4 v12, s[52:55], s70 offen offset:3072 sc1 lds
    s_add_u32 s70, s70, 4096
    s_mov_b32 m0, 17920
    s_nop 0
    buffer_load_dwordx4 v12, s[52:55], s70 offen offset:0 sc1 lds
    buffer_load_dwordx4 v12, s[52:55], s70 offen offset:1024 sc1 lds
    buffer_load_dwordx4 v12, s[52:55], s70 offen offset:2048 sc1 lds
    buffer_load_dwordx4 v12, s[52:55], s70 offen offset:3072 sc1 lds
    s_add_u32 s70, s70, 4096
    s_mov_b32 m0, 22016
    s_nop 0
    buffer_load_dwordx4 v12, s[52:55], s70 offen offset:0 sc1 lds
    buffer_load_dwordx4 v12, s[52:55], s70 offen offset:1024 sc1 lds
    s_waitcnt vmcnt(0) lgkmcnt(0)
    s_barrier
    s_cmp_lg_u32 s41, 0
    s_cbranch_scc1 L_end
    s_lshl_b32 s45, s42, 7
    v_mov_b32 v9, s43
    s_mov_b64 exec, 1
    buffer_store_dword v9, off, s[52:55], s45 sc1
    s_mov_b64 exec, -1
    s_endpgm
L_rt_body:
    v_add_u32 v9, 0, v1
    v_mul_u32_u24 v2, 6554, v9
    v_lshrrev_b32 v2, 16, v2
    v_mul_u32_u24 v2, 1120, v2
    v_lshl_add_u32 v2, v9, 4, v2
    v_add_u32 v9, 64, v1
    v_mul_u32_u24 v3, 6554, v9
    v_lshrrev_b32 v3, 16, v3
    v_mul_u32_u24 v3, 1120, v3
    v_lshl_add_u32 v3, v9, 4, v3
    v_add_u32 v9, 128, v1
    v_mul_u32_u24 v4, 6554, v9
    v_lshrrev_b32 v4, 16, v4
    v_mul_u32_u24 v4, 1120, v4
    v_lshl_add_u32 v4, v9, 4, v4
    v_add_u32 v9, 192, v1
    v_mul_u32_u24 v5, 6554, v9
    v_lshrrev_b32 v5, 16, v5
    v_mul_u32_u24 v5, 1120, v5
    v_lshl_add_u32 v5, v9, 4, v5
    v_add_u32 v9, 256, v1
    v_mul_u32_u24 v6, 6554, v9
    v_lshrrev_b32 v6, 16, v6
    v_mul_u32_u24 v6, 1120, v6
    v_lshl_add_u32 v6, v9, 4, v6
    s_lshr_b32 s46, s41, 1
    s_mul_i32 s68, s46, 122880
    s_mul_i32 s45, s98, 160
    s_add_u32 s68, s68, s45
    s_waitcnt lgkmcnt(0)
    s_mov_b32 s56, s28
    s_mov_b32 s57, s29
    s_mov_b32 s58, 0x1e0000
    s_mov_b32 s59, 0x20000
    s_mov_b32 s52, s38
    s_mov_b32 s53, s39
    s_mov_b32 s54, 0x1000000
    s_mov_b32 s55, 0x20000
    v_mov_b32 v10, 27648
    s_mov_b32 m0, 9216
    s_nop 0
    buffer_load_dwordx4 v2, s[56:59], s68 offen lds
    s_mov_b32 m0, 10240
    s_nop 0
    buffer_load_dwordx4 v3, s[56:59], s68 offen lds
    s_mov_b32 m0, 11264
    s_nop 0
    buffer_load_dwordx4 v4, s[56:59], s68 offen lds
    s_mov_b32 m0, 12288
    s_nop 0
    buffer_load_dwordx4 v5, s[56:59], s68 offen lds
    s_mov_b32 m0, 13312
    s_nop 0
    buffer_load_dwordx4 v6, s[56:59], s68 offen lds
    s_add_u32 s68, s68, 40960
    s_mov_b32 m0, 14336
    s_nop 0
    buffer_load_dwordx4 v2, s[56:59], s68 offen lds
    s_mov_b32 m0, 15360
    s_nop 0
    buffer_load_dwordx4 v3, s[56:59], s68 offen lds
    s_mov_b32 m0, 16384
    s_nop 0
    buffer_load_dwordx4 v4, s[56:59], s68 offen lds
    s_mov_b32 m0, 17408
    s_nop 0
    buffer_load_dwordx4 v5, s[56:59], s68 offen lds
    s_mov_b32 m0, 18432
    s_nop 0
    buffer_load_dwordx4 v6, s[56:59], s68 offen lds
    s_add_u32 s68, s68, 40960
    s_mov_b32 m0, 19456
    s_nop 0
    buffer_load_dwordx4 v2, s[56:59], s68 offen lds
    s_mov_b32 m0, 20480
    s_nop 0
    buffer_load_dwordx4 v3, s[56:59], s68 offen lds
    s_mov_b32 m0, 21504
    s_nop 0
    buffer_load_dwordx4 v4, s[56:59], s68 offen lds
    s_mov_b32 m0, 22528
    s_nop 0
    buffer_load_dwordx4 v5, s[56:59], s68 offen lds
    s_mov_b32 m0, 23552
    s_nop 0
    buffer_load_dwordx4 v6, s[56:59], s68 offen lds
    s_add_u32 s68, s68, 40960
    v_lshlrev_b32 v7, 4, v1
    v_mul_u32_u24 v8, 40, v1
    v_mov_b32 v10, 27648
    v_mov_b32 v9, 1
    s_lshl_b32 s69, s98, 4
    s_add_u32 s69, s69, s46
    s_mul_i32 s69, s69, 15360
    s_add_u32 s69, s69, 6815744
    s_waitcnt vmcnt(10)
    ds_read_b64_tr_b16 v[16:17], v8 offset:9216
    ds_read_b64_tr_b16 v[18:19], v8 offset:11776
    ds_read_b64_tr_b16 v[20:21], v8 offset:9224
    ds_read_b64_tr_b16 v[22:23], v8 offset:11784
    ds_read_b64_tr_b16 v[24:25], v8 offset:9232
    ds_read_b64_tr_b16 v[26:27], v8 offset:11792
    ds_read_b64_tr_b16 v[28:29], v8 offset:9240
    ds_read_b64_tr_b16 v[30:31], v8 offset:11800
    ds_read_b64_tr_b16 v[32:33], v8 offset:9248
    ds_read_b64_tr_b16 v[34:35], v8 offset:11808
    s_waitcnt vmcnt(5)
    ds_read_b64_tr_b16 v[36:37], v8 offset:14336
    ds_read_b64_tr_b16 v[38:39], v8 offset:16896
    ds_read_b64_tr_b16 v[40:41], v8 offset:14344
    ds_read_b64_tr_b16 v[42:43], v8 offset:16904
    ds_read_b64_tr_b16 v[44:45], v8 offset:14352
    ds_read_b64_tr_b16 v[46:47], v8 offset:16912
    ds_read_b64_tr_b16 v[48:49], v8 offset:14360
    ds_read_b64_tr_b16 v[50:51], v8 offset:16920
    ds_read_b64_tr_b16 v[52:53], v8 offset:14368
    ds_read_b64_tr_b16 v[54:55], v8 offset:16928
    s_waitcnt vmcnt(0)
    ds_read_b64_tr_b16 v[56:57], v8 offset:19456
    ds_read_b64_tr_b16 v[58:59], v8 offset:22016
    ds_read_b64_tr_b16 v[60:61], v8 offset:19464
    ds_read_b64_tr_b16 v[62:63], v8 offset:22024
    ds_read_b64_tr_b16 v[64:65], v8 offset:19472
    ds_read_b64_tr_b16 v[66:67], v8 offset:22032
    ds_read_b64_tr_b16 v[68:69], v8 offset:19480
    ds_read_b64_tr_b16 v[70:71], v8 offset:22040
    ds_read_b64_tr_b16 v[72:73], v8 offset:19488
    ds_read_b64_tr_b16 v[74:75], v8 offset:22048
    s_waitcnt lgkmcnt(15)
    buffer_store_dwordx4 v[16:19], v7, s[52:55], s69 offen offset:0 sc1
    buffer_store_dwordx4 v[20:23], v7, s[52:55], s69 offen offset:1024 sc1
    buffer_store_dwordx4 v[24:27], v7, s[52:55], s69 offen offset:2048 sc1
    buffer_store_dwordx4 v[28:31], v7, s[52:55], s69 offen offset:3072 sc1
    s_add_u32 s69, s69, 4096
    buffer_store_dwordx4 v[32:35], v7, s[52:55], s69 offen offset:0 sc1
    buffer_store_dwordx4 v[36:39], v7, s[52:55], s69 offen offset:1024 sc1
    buffer_store_dwordx4 v[40:43], v7, s[52:55], s69 offen offset:2048 sc1
    s_waitcnt lgkmcnt(14)
    buffer_store_dwordx4 v[44:47], v7, s[52:55], s69 offen offset:3072 sc1
    s_add_u32 s69, s69, 4096
    s_waitcnt lgkmcnt(12)
    buffer_store_dwordx4 v[48:51], v7, s[52:55], s69 offen offset:0 sc1
    s_waitcnt lgkmcnt(10)
    buffer_store_dwordx4 v[52:55], v7, s[52:55], s69 offen offset:1024 sc1
    s_waitcnt lgkmcnt(8)
    buffer_store_dwordx4 v[56:59], v7, s[52:55], s69 offen offset:2048 sc1
    s_waitcnt lgkmcnt(6)
    buffer_store_dwordx4 v[60:63], v7, s[52:55], s69 offen offset:3072 sc1
    s_add_u32 s69, s69, 4096
    s_waitcnt lgkmcnt(4)
    buffer_store_dwordx4 v[64:67], v7, s[52:55], s69 offen offset:0 sc1
    s_waitcnt lgkmcnt(2)
    buffer_store_dwordx4 v[68:71], v7, s[52:55], s69 offen offset:1024 sc1
    s_waitcnt lgkmcnt(0)
    buffer_store_dwordx4 v[72:75], v7, s[52:55], s69 offen offset:2048 sc1
    s_waitcnt vmcnt(0) lgkmcnt(0)
    ds_write_b32 v10, v9 offset:12
    s_endpgm
L_end:
    s_endpgm
.section .rodata,"a"
.p2align 6
.amdhsa_kernel gated_mix__ssm_conv_s4__dense_activation_squared_relu__prompt_kernel
  .amdhsa_next_free_vgpr 256
  .amdhsa_next_free_sgpr 102
  .amdhsa_accum_offset 256
  .amdhsa_group_segment_fixed_size 0
  .amdhsa_kernarg_size 144
  .amdhsa_user_sgpr_count 2
  .amdhsa_user_sgpr_kernarg_segment_ptr 1
  .amdhsa_system_sgpr_workgroup_id_x 1
.end_amdhsa_kernel
```
